```python
import torch

def _softmax(x, axis=-1):
    return torch.softmax(x, dim=axis)
def _gelu(x):
    return torch.nn.functional.gelu(x, approximate="tanh")
def _silu(x):
    return torch.nn.functional.silu(x)
def _sigmoid(x):
    return torch.sigmoid(x)
def _layernorm(x, axis=-1, eps=1e-5):
    m = x.mean(dim=axis, keepdim=True)
    v = x.var(dim=axis, keepdim=True, unbiased=False)
    return (x - m) / torch.sqrt(v + eps)
def _scatter_add(tgt, idx, src, axis=0):
    return tgt.clone().index_add_(axis, idx, src)
def _segment_sum(src, seg, n):
    out = torch.zeros((n,) + src.shape[1:], dtype=src.dtype)
    return out.index_add_(0, seg, src)
def _pad(x, pw):
    flat = tuple(v for pair in reversed(pw) for v in pair)
    return torch.nn.functional.pad(x, flat)

kernel_name = 'concat_heads__linear_kernel_hedgehog__ssm_conv_s4d__prompt'

def setup_inputs():

    _w = (lambda a: (lambda t: t.to(torch.bfloat16) if t.is_floating_point() else t)(torch.as_tensor(a)))
    def _A_setup():
        B, S, D, H = 1, 2048, 448, 16
        Dh = D // H
        return {
            "x": _w((lambda *s: torch.randn(*s, dtype=torch.bfloat16) * 0.4)(B, S, D)),
            "wqkv": _w((lambda *s: torch.randn(*s, dtype=torch.bfloat16) * 0.4)(D, 3 * D)),
            "w_phi": _w((lambda *s: torch.randn(*s, dtype=torch.bfloat16) * 0.4)(H, Dh, Dh) * (Dh ** -0.5)),
            "wo": _w((lambda *s: torch.randn(*s, dtype=torch.bfloat16) * 0.05)(D, D)),
        }
    _A_in = _A_setup()

    def _B_setup():
        Bsz, L, D, N = 1, 2048, 448, 256
        return {
            "u": _w((lambda *s: torch.randn(*s, dtype=torch.bfloat16) * 0.05)(Bsz, L, D)),
            "log_A_real": _w((lambda *s: torch.randn(*s, dtype=torch.bfloat16) * 3.2)(D, N) * 0.5),
            "A_imag": _w((lambda *s: torch.randn(*s, dtype=torch.bfloat16) * 0.2)(D, N) * 3.14),
            "C_real": _w((lambda *s: torch.randn(*s, dtype=torch.bfloat16) * 3.2)(D, N) / N ** 0.5),
            "C_imag": _w((lambda *s: torch.randn(*s, dtype=torch.bfloat16) * 3.2)(D, N) / N ** 0.5),
            "log_dt": _w((lambda *s: torch.randn(*s, dtype=torch.bfloat16) * 0.2)(D) * 0.5 - 4.0),
            "D_skip": _w((lambda *s: torch.randn(*s, dtype=torch.bfloat16) * 0.4)(D)),
        }
    _B_in = _B_setup()

    return {
        "A_x": _A_in["x"],
        "A_wqkv": _A_in["wqkv"],
        "A_w_phi": _A_in["w_phi"],
        "A_wo": _A_in["wo"],
        "B_u": _B_in["u"],
        "B_log_A_real": _B_in["log_A_real"],
        "B_A_imag": _B_in["A_imag"],
        "B_C_real": _B_in["C_real"],
        "B_C_imag": _B_in["C_imag"],
        "B_log_dt": _B_in["log_dt"],
        "B_D_skip": _B_in["D_skip"],
    }

def reference(A_x, A_wqkv, A_w_phi, A_wo, B_u, B_log_A_real, B_A_imag, B_C_real, B_C_imag, B_log_dt, B_D_skip):
    def _A_ref(x, wqkv, w_phi, wo):
        B, S, D = x.shape
        H = 16; Dh = D // H
        qkv = (lambda x, *d: x.permute(*d))((x @ wqkv).reshape(B, S, 3, H, Dh), 2, 0, 3, 1, 4)
        q, k, v = qkv[0], qkv[1], qkv[2]
        pq = torch.einsum("bhsd,hdf->bhsf", q, w_phi)
        pk = torch.einsum("bhsd,hdf->bhsf", k, w_phi)
        phi_q = torch.concatenate([_softmax(pq, axis=-1), _softmax(-pq, axis=-1)], axis=-1)
        phi_k = torch.concatenate([_softmax(pk, axis=-1), _softmax(-pk, axis=-1)], axis=-1)
        kv = torch.einsum("bhsf,bhsd->bhfd", phi_k, v)
        z  = torch.einsum("bhsf->bhf", phi_k)
        num = torch.einsum("bhqf,bhfd->bhqd", phi_q, kv)
        den = torch.einsum("bhqf,bhf->bhq", phi_q, z)[..., None] + 1e-6
        o = num / den
        return (lambda x, *d: x.permute(*d))(o, 0, 2, 1, 3).reshape(B, S, D) @ wo

    def _B_ref(u, log_A_real, A_imag, C_real, C_imag, log_dt, D_skip):
        L = u.shape[1]
        dt = torch.exp(log_dt)
        A = -torch.exp(log_A_real) + 1j * A_imag
        C = (C_real + 1j * C_imag) * dt[:, None]
        pos = (lambda x, dt: x.to(dt))(torch.arange(L), log_dt.dtype)
        P = torch.exp((A * dt[:, None])[:, :, None] * pos[None, None, :])
        K = 2.0 * torch.einsum("dn,dnl->dl", C, P).real
        L2 = 2 * L
        u_t = (lambda x, *d: x.permute(*d))(u, 0, 2, 1)
        Kf = (lambda x, *a, **k: torch.fft.rfft(x.float(), *a, **k))(K, L2)
        Uf = (lambda x, *a, **k: torch.fft.rfft(x.float(), *a, **k))(u_t, L2)
        y = (lambda x, *a, **k: torch.fft.irfft(x, *a, **k).to(torch.bfloat16))(Uf * Kf[None, :, :], L2)[:, :, :L]
        y = (lambda x, *d: x.permute(*d))(y, 0, 2, 1)
        return y + u * D_skip[None, None, :]

    a = _A_ref(A_x, A_wqkv, A_w_phi, A_wo)
    b = _B_ref(B_u, B_log_A_real, B_A_imag, B_C_real, B_C_imag, B_log_dt, B_D_skip)
    return torch.concatenate([a, b], axis=-1)
```

```asm
; @launch grid=(481,1,1) block=(256,1,1) lds=81920
.amdgcn_target "amdgcn-amd-amdhsa--gfx950"
.text
.globl concat_heads__linear_kernel_hedgehog__ssm_conv_s4d__prompt_kernel
.p2align 8
.type concat_heads__linear_kernel_hedgehog__ssm_conv_s4d__prompt_kernel,@function
concat_heads__linear_kernel_hedgehog__ssm_conv_s4d__prompt_kernel:
    s_cmp_ge_u32 s2, 481
    s_cbranch_scc1 L_exit
    s_load_dwordx16 s[4:19], s[0:1], 0
    s_load_dwordx8 s[20:27], s[0:1], 64
    s_load_dwordx4 s[28:31], s[0:1], 96
    s_getpc_b64 s[62:63]
    s_bfe_u32 s39, s2, 0x20003
    s_mul_i32 s39, s39, 56
    v_add_u32 v2, s39, v0
    v_lshlrev_b32 v2, 7, v2
    v_min_u32 v2, L_exit-concat_heads__linear_kernel_hedgehog__ssm_conv_s4d__prompt_kernel-64, v2
    v_cmp_gt_u32 vcc, 56, v0
    s_nop 0
    s_and_saveexec_b64 s[40:41], vcc
    s_cbranch_execz L_nopf
    global_load_dword v255, v2, s[62:63]
L_nopf:
    s_mov_b64 exec, -1
    s_cmp_ge_u32 s2, 225
    s_cbranch_scc1 L_A
    s_cmp_eq_u32 s2, 224
    s_cbranch_scc1 L_ctrl
    s_setprio 3
    s_sub_u32 s32, s2, 0
    s_lshr_b32 s33, s32, 5
    s_and_b32 s34, s32, 31
    v_lshrrev_b32 v2, 6, v0
    v_and_b32 v1, 63, v0
    v_readfirstlane_b32 s35, v2
    s_lshl_b32 s45, s32, 2
    s_and_b32 s36, s35, 1
    s_lshr_b32 s37, s35, 1
    s_lshl_b32 s38, s32, 1
    s_add_u32 s38, s38, s37
    s_lshl_b32 s39, s38, 9
    s_lshl_b32 s42, s36, 8
    s_add_u32 s39, s39, s42
    v_lshl_add_u32 v3, v1, 2, s39
    s_waitcnt lgkmcnt(0)
    global_load_dword v20, v3, s[14:15]
    global_load_dword v21, v3, s[16:17]
    global_load_dword v22, v3, s[18:19]
    global_load_dword v23, v3, s[20:21]
    s_load_dword s40, s[22:23], s45
    s_load_dword s41, s[24:25], s45
    s_setprio 0
    s_mul_i32 s39, s34, 57344
    s_lshl_b32 s42, s33, 7
    s_add_u32 s39, s39, s42
    v_lshrrev_b32 v4, 3, v0
    v_and_b32 v5, 7, v0
    v_mul_u32_u24 v6, 896, v4
    v_lshl_add_u32 v6, v5, 4, v6
    v_add_u32 v6, s39, v6
    v_add_u32 v7, 28672, v6
    v_mul_u32_u24 v8, 160, v4
    v_lshl_add_u32 v8, v5, 4, v8
    v_add_u32 v8, 69632, v8
    v_lshrrev_b32 v9, 4, v1
    v_and_b32 v10, 15, v1
    v_lshrrev_b32 v11, 2, v10
    v_lshl_add_u32 v11, v9, 3, v11
    v_mul_u32_u24 v11, 160, v11
    v_and_b32 v24, 3, v10
    v_lshl_add_u32 v11, v24, 3, v11
    s_lshl_b32 s39, s35, 5
    s_add_u32 s39, s39, 69632
    v_add_u32 v11, s39, v11
    s_mul_i32 s39, s35, 2304
    s_add_u32 s39, s39, 69632
    v_mul_u32_u24 v112, 144, v10
    v_lshl_add_u32 v112, v9, 4, v112
    v_add_u32 v112, s39, v112
    v_lshrrev_b32 v113, 3, v1
    v_and_b32 v114, 7, v1
    v_mul_u32_u24 v115, 144, v113
    v_lshl_add_u32 v115, v114, 4, v115
    v_add_u32 v105, s39, v115
    v_mov_b32 v106, v112
    s_lshl_b32 s39, s33, 6
    s_lshl_b32 s42, s35, 4
    s_add_u32 s39, s39, s42
    s_lshl_b32 s39, s39, 12
    s_lshl_b32 s42, s34, 7
    s_add_u32 s39, s39, s42
    s_add_u32 s39, s39, 6291456
    v_lshlrev_b32 v24, 12, v113
    v_lshl_add_u32 v24, v114, 4, v24
    v_add_u32 v24, s39, v24
    v_add_u32 v25, 32768, v24
    s_lshl_b32 s39, s32, 13
    s_add_u32 s39, s39, 4194304
    v_lshl_add_u32 v30, v0, 4, s39
    v_add_u32 v31, 4096, v30
    v_mov_b32 v108, -1
    v_mov_b32 v109, -1
    v_mov_b32 v110, -1
    v_mov_b32 v111, -1
    v_mov_b32 v28, 0
    s_mul_i32 s39, s35, 17408
    s_mov_b32 m0, s39
    v_and_b32 v2, 31, v1
    v_mul_u32_u24 v104, 272, v2
    v_lshrrev_b32 v2, 5, v1
    v_lshl_add_u32 v104, v2, 4, v104
    v_add_u32 v104, s39, v104
    s_waitcnt lgkmcnt(0)
    s_lshl_b32 s39, s37, 4
    s_lshr_b32 s40, s40, s39
    s_lshl_b32 s40, s40, 16
    s_lshr_b32 s41, s41, s39
    s_lshl_b32 s41, s41, 16
    v_mov_b32 v26, s40
    v_mul_f32 v26, 0x3fb8aa3b, v26
    v_exp_f32 v26, v26
    s_nop 0
    v_cvt_pk_bf16_f32 v26, v26, v26
    v_lshlrev_b32 v26, 16, v26
    v_add_f32 v27, v26, v26
    v_mov_b32 v32, 0
    v_mov_b32 v33, 0
    v_mov_b32 v34, 0
    v_mov_b32 v35, 0
    v_mov_b32 v36, 0
    v_mov_b32 v37, 0
    v_mov_b32 v38, 0
    v_mov_b32 v39, 0
    v_mov_b32 v40, 0
    v_mov_b32 v41, 0
    v_mov_b32 v42, 0
    v_mov_b32 v43, 0
    v_mov_b32 v44, 0
    v_mov_b32 v45, 0
    v_mov_b32 v46, 0
    v_mov_b32 v47, 0
    s_waitcnt vmcnt(0)
    s_setprio 3
    global_load_dwordx4 v[12:15], v6, s[12:13]
    global_load_dwordx4 v[16:19], v7, s[12:13]
    s_setprio 0
    v_lshlrev_b32 v2, 16, v20
    v_lshlrev_b32 v3, 16, v21
    v_lshlrev_b32 v4, 16, v22
    v_lshlrev_b32 v5, 16, v23
    v_mul_f32 v2, 0x3fb8aa3b, v2
    v_exp_f32 v2, v2
    v_mul_f32 v3, v3, v26
    v_cvt_pk_bf16_f32 v2, v2, v2
    v_lshlrev_b32 v2, 16, v2
    v_mul_f32 v2, v2, v26
    v_mul_f32 v71, 0x3e22f983, v3
    v_mul_f32 v70, 0xbfb8aa3b, v2
    v_mul_f32 v62, v4, v27
    v_mul_f32 v63, v5, v27
    v_exp_f32 v112, v70
    v_fract_f32 v113, v71
    v_cos_f32 v114, v113
    v_sin_f32 v115, v113
    v_mul_f32 v48, v112, v114
    v_mul_f32 v49, v112, v115
    v_mul_f32 v116, 0x41000000, v70
    v_mul_f32 v117, 0x41000000, v71
    v_exp_f32 v116, v116
    v_fract_f32 v117, v117
    v_cos_f32 v118, v117
    v_sin_f32 v119, v117
    v_mul_f32 v54, v116, v118
    v_mul_f32 v55, v116, v119
    v_mul_f32 v120, 0x43800000, v70
    v_mul_f32 v121, 0x43800000, v71
    v_exp_f32 v120, v120
    v_fract_f32 v121, v121
    v_cos_f32 v122, v121
    v_sin_f32 v123, v121
    v_mul_f32 v56, v120, v122
    v_mul_f32 v57, v120, v123
    v_pk_mul_f32 v[64:65], v[48:49], v[48:49] op_sel_hi:[1,0]
    v_pk_fma_f32 v[50:51], v[48:49], v[48:49], v[64:65] op_sel:[1,1,0] op_sel_hi:[0,1,1] neg_lo:[0,1,0]
    v_pk_mul_f32 v[64:65], v[50:51], v[50:51] op_sel_hi:[1,0]
    v_pk_fma_f32 v[52:53], v[50:51], v[50:51], v[64:65] op_sel:[1,1,0] op_sel_hi:[0,1,1] neg_lo:[0,1,0]
    v_cvt_pk_bf16_f32 v68, v62, -v63
    v_mov_b32 v69, 0x3f80
    ds_write_addtid_b32 v68 offset:8704
    ds_write_addtid_b32 v69 offset:0
    v_pk_mul_f32 v[64:65], v[62:63], v[48:49] op_sel_hi:[1,0]
    v_cvt_pk_bf16_f32 v69, v54, v55
    v_pk_fma_f32 v[58:59], v[62:63], v[48:49], v[64:65] op_sel:[1,1,0] op_sel_hi:[0,1,1] neg_lo:[0,1,0]
    ds_write_addtid_b32 v69 offset:272
    v_cvt_pk_bf16_f32 v68, v58, -v59
    ds_write_addtid_b32 v68 offset:8976
    v_pk_mul_f32 v[64:65], v[58:59], v[48:49] op_sel_hi:[1,0]
    v_pk_mul_f32 v[66:67], v[54:55], v[54:55] op_sel_hi:[1,0]
    v_pk_fma_f32 v[58:59], v[58:59], v[48:49], v[64:65] op_sel:[1,1,0] op_sel_hi:[0,1,1] neg_lo:[0,1,0]
    v_pk_fma_f32 v[60:61], v[54:55], v[54:55], v[66:67] op_sel:[1,1,0] op_sel_hi:[0,1,1] neg_lo:[0,1,0]
    v_cvt_pk_bf16_f32 v68, v58, -v59
    v_cvt_pk_bf16_f32 v69, v60, v61
    ds_write_addtid_b32 v68 offset:9248
    ds_write_addtid_b32 v69 offset:544
    v_pk_mul_f32 v[64:65], v[58:59], v[48:49] op_sel_hi:[1,0]
    v_pk_mul_f32 v[66:67], v[60:61], v[54:55] op_sel_hi:[1,0]
    v_pk_fma_f32 v[58:59], v[58:59], v[48:49], v[64:65] op_sel:[1,1,0] op_sel_hi:[0,1,1] neg_lo:[0,1,0]
    v_pk_fma_f32 v[60:61], v[60:61], v[54:55], v[66:67] op_sel:[1,1,0] op_sel_hi:[0,1,1] neg_lo:[0,1,0]
    v_cvt_pk_bf16_f32 v68, v58, -v59
    v_cvt_pk_bf16_f32 v69, v60, v61
    ds_write_addtid_b32 v68 offset:9520
    ds_write_addtid_b32 v69 offset:816
    v_pk_mul_f32 v[64:65], v[58:59], v[48:49] op_sel_hi:[1,0]
    v_pk_mul_f32 v[66:67], v[60:61], v[54:55] op_sel_hi:[1,0]
    v_pk_fma_f32 v[58:59], v[58:59], v[48:49], v[64:65] op_sel:[1,1,0] op_sel_hi:[0,1,1] neg_lo:[0,1,0]
    v_pk_fma_f32 v[60:61], v[60:61], v[54:55], v[66:67] op_sel:[1,1,0] op_sel_hi:[0,1,1] neg_lo:[0,1,0]
    v_cvt_pk_bf16_f32 v68, v58, -v59
    v_cvt_pk_bf16_f32 v69, v60, v61
    ds_write_addtid_b32 v68 offset:9792
    ds_write_addtid_b32 v69 offset:1088
    v_pk_mul_f32 v[64:65], v[58:59], v[48:49] op_sel_hi:[1,0]
    v_pk_mul_f32 v[66:67], v[60:61], v[54:55] op_sel_hi:[1,0]
    v_pk_fma_f32 v[58:59], v[58:59], v[48:49], v[64:65] op_sel:[1,1,0] op_sel_hi:[0,1,1] neg_lo:[0,1,0]
    v_pk_fma_f32 v[60:61], v[60:61], v[54:55], v[66:67] op_sel:[1,1,0] op_sel_hi:[0,1,1] neg_lo:[0,1,0]
    v_cvt_pk_bf16_f32 v68, v58, -v59
    v_cvt_pk_bf16_f32 v69, v60, v61
    ds_write_addtid_b32 v68 offset:10064
    ds_write_addtid_b32 v69 offset:1360
    v_pk_mul_f32 v[64:65], v[58:59], v[48:49] op_sel_hi:[1,0]
    v_pk_mul_f32 v[66:67], v[60:61], v[54:55] op_sel_hi:[1,0]
    v_pk_fma_f32 v[58:59], v[58:59], v[48:49], v[64:65] op_sel:[1,1,0] op_sel_hi:[0,1,1] neg_lo:[0,1,0]
    v_pk_fma_f32 v[60:61], v[60:61], v[54:55], v[66:67] op_sel:[1,1,0] op_sel_hi:[0,1,1] neg_lo:[0,1,0]
    v_cvt_pk_bf16_f32 v68, v58, -v59
    v_cvt_pk_bf16_f32 v69, v60, v61
    ds_write_addtid_b32 v68 offset:10336
    ds_write_addtid_b32 v69 offset:1632
    v_pk_mul_f32 v[64:65], v[58:59], v[48:49] op_sel_hi:[1,0]
    v_pk_mul_f32 v[66:67], v[60:61], v[54:55] op_sel_hi:[1,0]
    v_pk_fma_f32 v[58:59], v[58:59], v[48:49], v[64:65] op_sel:[1,1,0] op_sel_hi:[0,1,1] neg_lo:[0,1,0]
    v_pk_fma_f32 v[60:61], v[60:61], v[54:55], v[66:67] op_sel:[1,1,0] op_sel_hi:[0,1,1] neg_lo:[0,1,0]
    v_cvt_pk_bf16_f32 v68, v58, -v59
    v_cvt_pk_bf16_f32 v69, v60, v61
    ds_write_addtid_b32 v68 offset:10608
    ds_write_addtid_b32 v69 offset:1904
    v_pk_mul_f32 v[64:65], v[62:63], v[56:57] op_sel_hi:[1,0]
    v_pk_mul_f32 v[66:67], v[60:61], v[54:55] op_sel_hi:[1,0]
    v_pk_fma_f32 v[62:63], v[62:63], v[56:57], v[64:65] op_sel:[1,1,0] op_sel_hi:[0,1,1] neg_lo:[0,1,0]
    v_pk_fma_f32 v[60:61], v[60:61], v[54:55], v[66:67] op_sel:[1,1,0] op_sel_hi:[0,1,1] neg_lo:[0,1,0]
    v_cvt_pk_bf16_f32 v68, v62, -v63
    v_cvt_pk_bf16_f32 v69, v60, v61
    ds_write_addtid_b32 v68 offset:10880
    ds_write_addtid_b32 v69 offset:2176
    ds_write_addtid_b32 v68 offset:11152
    v_pk_mul_f32 v[64:65], v[62:63], v[50:51] op_sel_hi:[1,0]
    v_pk_mul_f32 v[66:67], v[60:61], v[54:55] op_sel_hi:[1,0]
    v_pk_fma_f32 v[58:59], v[62:63], v[50:51], v[64:65] op_sel:[1,1,0] op_sel_hi:[0,1,1] neg_lo:[0,1,0]
    v_pk_fma_f32 v[60:61], v[60:61], v[54:55], v[66:67] op_sel:[1,1,0] op_sel_hi:[0,1,1] neg_lo:[0,1,0]
    v_cvt_pk_bf16_f32 v68, v58, -v59
    v_cvt_pk_bf16_f32 v69, v60, v61
    ds_write_addtid_b32 v68 offset:11424
    ds_write_addtid_b32 v69 offset:2448
    v_pk_mul_f32 v[64:65], v[58:59], v[50:51] op_sel_hi:[1,0]
    v_pk_mul_f32 v[66:67], v[60:61], v[54:55] op_sel_hi:[1,0]
    v_pk_fma_f32 v[58:59], v[58:59], v[50:51], v[64:65] op_sel:[1,1,0] op_sel_hi:[0,1,1] neg_lo:[0,1,0]
    v_pk_fma_f32 v[60:61], v[60:61], v[54:55], v[66:67] op_sel:[1,1,0] op_sel_hi:[0,1,1] neg_lo:[0,1,0]
    v_cvt_pk_bf16_f32 v68, v58, -v59
    v_cvt_pk_bf16_f32 v69, v60, v61
    ds_write_addtid_b32 v68 offset:11696
    ds_write_addtid_b32 v69 offset:2720
    ds_write_addtid_b32 v68 offset:11968
    ds_write_addtid_b32 v68 offset:12240
    v_pk_mul_f32 v[64:65], v[58:59], v[50:51] op_sel_hi:[1,0]
    v_pk_mul_f32 v[66:67], v[60:61], v[54:55] op_sel_hi:[1,0]
    v_pk_fma_f32 v[58:59], v[58:59], v[50:51], v[64:65] op_sel:[1,1,0] op_sel_hi:[0,1,1] neg_lo:[0,1,0]
    v_pk_fma_f32 v[60:61], v[60:61], v[54:55], v[66:67] op_sel:[1,1,0] op_sel_hi:[0,1,1] neg_lo:[0,1,0]
    v_cvt_pk_bf16_f32 v68, v58, -v59
    v_cvt_pk_bf16_f32 v69, v60, v61
    ds_write_addtid_b32 v68 offset:12512
    ds_write_addtid_b32 v69 offset:2992
    v_pk_mul_f32 v[64:65], v[58:59], v[50:51] op_sel_hi:[1,0]
    v_pk_mul_f32 v[66:67], v[60:61], v[54:55] op_sel_hi:[1,0]
    v_pk_fma_f32 v[58:59], v[58:59], v[50:51], v[64:65] op_sel:[1,1,0] op_sel_hi:[0,1,1] neg_lo:[0,1,0]
    v_pk_fma_f32 v[60:61], v[60:61], v[54:55], v[66:67] op_sel:[1,1,0] op_sel_hi:[0,1,1] neg_lo:[0,1,0]
    v_cvt_pk_bf16_f32 v68, v58, -v59
    v_cvt_pk_bf16_f32 v69, v60, v61
    ds_write_addtid_b32 v68 offset:12784
    ds_write_addtid_b32 v69 offset:3264
    v_pk_mul_f32 v[64:65], v[62:63], v[56:57] op_sel_hi:[1,0]
    v_pk_mul_f32 v[66:67], v[60:61], v[54:55] op_sel_hi:[1,0]
    v_pk_fma_f32 v[62:63], v[62:63], v[56:57], v[64:65] op_sel:[1,1,0] op_sel_hi:[0,1,1] neg_lo:[0,1,0]
    v_pk_fma_f32 v[60:61], v[60:61], v[54:55], v[66:67] op_sel:[1,1,0] op_sel_hi:[0,1,1] neg_lo:[0,1,0]
    v_cvt_pk_bf16_f32 v68, v62, -v63
    v_cvt_pk_bf16_f32 v69, v60, v61
    ds_write_addtid_b32 v68 offset:13056
    ds_write_addtid_b32 v69 offset:3536
    v_pk_mul_f32 v[64:65], v[62:63], v[52:53] op_sel_hi:[1,0]
    v_pk_mul_f32 v[66:67], v[60:61], v[54:55] op_sel_hi:[1,0]
    v_pk_fma_f32 v[58:59], v[62:63], v[52:53], v[64:65] op_sel:[1,1,0] op_sel_hi:[0,1,1] neg_lo:[0,1,0]
    v_pk_fma_f32 v[60:61], v[60:61], v[54:55], v[66:67] op_sel:[1,1,0] op_sel_hi:[0,1,1] neg_lo:[0,1,0]
    v_cvt_pk_bf16_f32 v68, v58, -v59
    v_cvt_pk_bf16_f32 v69, v60, v61
    ds_write_addtid_b32 v68 offset:13328
    ds_write_addtid_b32 v69 offset:3808
    v_pk_mul_f32 v[64:65], v[58:59], v[52:53] op_sel_hi:[1,0]
    v_pk_mul_f32 v[66:67], v[60:61], v[54:55] op_sel_hi:[1,0]
    v_pk_fma_f32 v[58:59], v[58:59], v[52:53], v[64:65] op_sel:[1,1,0] op_sel_hi:[0,1,1] neg_lo:[0,1,0]
    v_pk_fma_f32 v[60:61], v[60:61], v[54:55], v[66:67] op_sel:[1,1,0] op_sel_hi:[0,1,1] neg_lo:[0,1,0]
    v_cvt_pk_bf16_f32 v68, v58, -v59
    v_cvt_pk_bf16_f32 v69, v60, v61
    ds_write_addtid_b32 v68 offset:13600
    ds_write_addtid_b32 v69 offset:4080
    v_pk_mul_f32 v[64:65], v[62:63], v[56:57] op_sel_hi:[1,0]
    v_pk_mul_f32 v[66:67], v[60:61], v[54:55] op_sel_hi:[1,0]
    v_pk_fma_f32 v[62:63], v[62:63], v[56:57], v[64:65] op_sel:[1,1,0] op_sel_hi:[0,1,1] neg_lo:[0,1,0]
    v_pk_fma_f32 v[60:61], v[60:61], v[54:55], v[66:67] op_sel:[1,1,0] op_sel_hi:[0,1,1] neg_lo:[0,1,0]
    v_cvt_pk_bf16_f32 v68, v62, -v63
    v_cvt_pk_bf16_f32 v69, v60, v61
    ds_write_addtid_b32 v68 offset:14144
    ds_write_addtid_b32 v69 offset:4352
    s_waitcnt vmcnt(0)
    ds_write_b128 v8, v[12:15]
    ds_write_b128 v8, v[16:19] offset:5120
    v_pk_mul_f32 v[64:65], v[62:63], v[52:53] op_sel_hi:[1,0]
    v_pk_mul_f32 v[66:67], v[60:61], v[54:55] op_sel_hi:[1,0]
    v_pk_fma_f32 v[58:59], v[62:63], v[52:53], v[64:65] op_sel:[1,1,0] op_sel_hi:[0,1,1] neg_lo:[0,1,0]
    v_pk_fma_f32 v[60:61], v[60:61], v[54:55], v[66:67] op_sel:[1,1,0] op_sel_hi:[0,1,1] neg_lo:[0,1,0]
    v_cvt_pk_bf16_f32 v68, v58, -v59
    v_cvt_pk_bf16_f32 v69, v60, v61
    ds_write_addtid_b32 v68 offset:14416
    ds_write_addtid_b32 v69 offset:4624
    v_pk_mul_f32 v[64:65], v[58:59], v[52:53] op_sel_hi:[1,0]
    v_pk_mul_f32 v[66:67], v[60:61], v[54:55] op_sel_hi:[1,0]
    v_pk_fma_f32 v[58:59], v[58:59], v[52:53], v[64:65] op_sel:[1,1,0] op_sel_hi:[0,1,1] neg_lo:[0,1,0]
    v_pk_fma_f32 v[60:61], v[60:61], v[54:55], v[66:67] op_sel:[1,1,0] op_sel_hi:[0,1,1] neg_lo:[0,1,0]
    v_cvt_pk_bf16_f32 v68, v58, -v59
    v_cvt_pk_bf16_f32 v69, v60, v61
    ds_write_addtid_b32 v68 offset:14688
    ds_write_addtid_b32 v69 offset:4896
    v_pk_mul_f32 v[64:65], v[62:63], v[56:57] op_sel_hi:[1,0]
    v_pk_mul_f32 v[66:67], v[60:61], v[54:55] op_sel_hi:[1,0]
    v_pk_fma_f32 v[62:63], v[62:63], v[56:57], v[64:65] op_sel:[1,1,0] op_sel_hi:[0,1,1] neg_lo:[0,1,0]
    v_pk_fma_f32 v[60:61], v[60:61], v[54:55], v[66:67] op_sel:[1,1,0] op_sel_hi:[0,1,1] neg_lo:[0,1,0]
    v_cvt_pk_bf16_f32 v68, v62, -v63
    v_cvt_pk_bf16_f32 v69, v60, v61
    ds_write_addtid_b32 v68 offset:15232
    ds_write_addtid_b32 v69 offset:5168
    s_waitcnt lgkmcnt(0)
    s_barrier
    ds_read_b64_tr_b16 v[12:13], v11
    ds_read_b64_tr_b16 v[14:15], v11 offset:640
    ds_read_b64_tr_b16 v[16:17], v11 offset:5120
    ds_read_b64_tr_b16 v[18:19], v11 offset:5760
    s_waitcnt lgkmcnt(0)
    s_barrier
    ds_write_b128 v106, v[12:15]
    ds_write_b128 v106, v[16:19] offset:64
    ds_read_b128 v[12:15], v105
    ds_read_b128 v[16:19], v105 offset:1152
    s_waitcnt lgkmcnt(0)
    s_setprio 3
    global_store_dwordx4 v24, v[12:15], s[30:31] sc1
    global_store_dwordx4 v25, v[16:19], s[30:31] sc1
    global_store_dwordx4 v30, v[108:111], s[30:31] sc1
    global_store_dwordx4 v31, v[108:111], s[30:31] sc1
    global_load_dword v29, v28, s[28:29] sc1
    s_setprio 0
    v_pk_mul_f32 v[64:65], v[62:63], v[54:55] op_sel_hi:[1,0]
    v_pk_mul_f32 v[66:67], v[60:61], v[54:55] op_sel_hi:[1,0]
    v_pk_fma_f32 v[58:59], v[62:63], v[54:55], v[64:65] op_sel:[1,1,0] op_sel_hi:[0,1,1] neg_lo:[0,1,0]
    v_pk_fma_f32 v[60:61], v[60:61], v[54:55], v[66:67] op_sel:[1,1,0] op_sel_hi:[0,1,1] neg_lo:[0,1,0]
    v_cvt_pk_bf16_f32 v68, v58, -v59
    v_cvt_pk_bf16_f32 v69, v60, v61
    ds_write_addtid_b32 v68 offset:15504
    ds_write_addtid_b32 v69 offset:5440
    v_pk_mul_f32 v[64:65], v[62:63], v[56:57] op_sel_hi:[1,0]
    v_pk_mul_f32 v[66:67], v[60:61], v[54:55] op_sel_hi:[1,0]
    v_pk_fma_f32 v[62:63], v[62:63], v[56:57], v[64:65] op_sel:[1,1,0] op_sel_hi:[0,1,1] neg_lo:[0,1,0]
    v_pk_fma_f32 v[60:61], v[60:61], v[54:55], v[66:67] op_sel:[1,1,0] op_sel_hi:[0,1,1] neg_lo:[0,1,0]
    v_cvt_pk_bf16_f32 v68, v62, -v63
    v_cvt_pk_bf16_f32 v69, v60, v61
    ds_write_addtid_b32 v68 offset:15776
    ds_write_addtid_b32 v69 offset:5712
    v_pk_mul_f32 v[64:65], v[62:63], v[54:55] op_sel_hi:[1,0]
    v_pk_mul_f32 v[66:67], v[60:61], v[54:55] op_sel_hi:[1,0]
    v_pk_fma_f32 v[58:59], v[62:63], v[54:55], v[64:65] op_sel:[1,1,0] op_sel_hi:[0,1,1] neg_lo:[0,1,0]
    v_pk_fma_f32 v[60:61], v[60:61], v[54:55], v[66:67] op_sel:[1,1,0] op_sel_hi:[0,1,1] neg_lo:[0,1,0]
    v_cvt_pk_bf16_f32 v68, v58, -v59
    v_cvt_pk_bf16_f32 v69, v60, v61
    ds_write_addtid_b32 v68 offset:16048
    ds_write_addtid_b32 v69 offset:5984
    v_pk_mul_f32 v[64:65], v[62:63], v[56:57] op_sel_hi:[1,0]
    v_pk_mul_f32 v[66:67], v[60:61], v[54:55] op_sel_hi:[1,0]
    v_pk_fma_f32 v[62:63], v[62:63], v[56:57], v[64:65] op_sel:[1,1,0] op_sel_hi:[0,1,1] neg_lo:[0,1,0]
    v_pk_fma_f32 v[60:61], v[60:61], v[54:55], v[66:67] op_sel:[1,1,0] op_sel_hi:[0,1,1] neg_lo:[0,1,0]
    v_cvt_pk_bf16_f32 v68, v62, -v63
    v_cvt_pk_bf16_f32 v69, v60, v61
    ds_write_addtid_b32 v68 offset:16320
    ds_write_addtid_b32 v69 offset:6256
    v_pk_mul_f32 v[64:65], v[62:63], v[54:55] op_sel_hi:[1,0]
    v_pk_mul_f32 v[66:67], v[60:61], v[54:55] op_sel_hi:[1,0]
    v_pk_fma_f32 v[58:59], v[62:63], v[54:55], v[64:65] op_sel:[1,1,0] op_sel_hi:[0,1,1] neg_lo:[0,1,0]
    v_pk_fma_f32 v[60:61], v[60:61], v[54:55], v[66:67] op_sel:[1,1,0] op_sel_hi:[0,1,1] neg_lo:[0,1,0]
    v_cvt_pk_bf16_f32 v68, v58, -v59
    v_cvt_pk_bf16_f32 v69, v60, v61
    ds_write_addtid_b32 v68 offset:16592
    ds_write_addtid_b32 v69 offset:6528
    v_pk_mul_f32 v[64:65], v[62:63], v[56:57] op_sel_hi:[1,0]
    v_pk_mul_f32 v[66:67], v[60:61], v[54:55] op_sel_hi:[1,0]
    v_pk_fma_f32 v[62:63], v[62:63], v[56:57], v[64:65] op_sel:[1,1,0] op_sel_hi:[0,1,1] neg_lo:[0,1,0]
    v_pk_fma_f32 v[60:61], v[60:61], v[54:55], v[66:67] op_sel:[1,1,0] op_sel_hi:[0,1,1] neg_lo:[0,1,0]
    v_cvt_pk_bf16_f32 v68, v62, -v63
    v_cvt_pk_bf16_f32 v69, v60, v61
    ds_write_addtid_b32 v68 offset:16864
    ds_write_addtid_b32 v69 offset:6800
    v_pk_mul_f32 v[64:65], v[62:63], v[54:55] op_sel_hi:[1,0]
    v_pk_mul_f32 v[66:67], v[60:61], v[54:55] op_sel_hi:[1,0]
    v_pk_fma_f32 v[58:59], v[62:63], v[54:55], v[64:65] op_sel:[1,1,0] op_sel_hi:[0,1,1] neg_lo:[0,1,0]
    v_pk_fma_f32 v[60:61], v[60:61], v[54:55], v[66:67] op_sel:[1,1,0] op_sel_hi:[0,1,1] neg_lo:[0,1,0]
    v_cvt_pk_bf16_f32 v68, v58, -v59
    v_cvt_pk_bf16_f32 v69, v60, v61
    ds_write_addtid_b32 v68 offset:17136
    ds_write_addtid_b32 v69 offset:7072
    v_pk_mul_f32 v[66:67], v[60:61], v[54:55] op_sel_hi:[1,0]
    v_pk_fma_f32 v[60:61], v[60:61], v[54:55], v[66:67] op_sel:[1,1,0] op_sel_hi:[0,1,1] neg_lo:[0,1,0]
    v_cvt_pk_bf16_f32 v69, v60, v61
    ds_write_addtid_b32 v69 offset:7344
    v_pk_mul_f32 v[66:67], v[60:61], v[54:55] op_sel_hi:[1,0]
    v_pk_fma_f32 v[60:61], v[60:61], v[54:55], v[66:67] op_sel:[1,1,0] op_sel_hi:[0,1,1] neg_lo:[0,1,0]
    v_cvt_pk_bf16_f32 v69, v60, v61
    ds_write_addtid_b32 v69 offset:7616
    v_pk_mul_f32 v[66:67], v[60:61], v[54:55] op_sel_hi:[1,0]
    v_pk_fma_f32 v[60:61], v[60:61], v[54:55], v[66:67] op_sel:[1,1,0] op_sel_hi:[0,1,1] neg_lo:[0,1,0]
    v_cvt_pk_bf16_f32 v69, v60, v61
    ds_write_addtid_b32 v69 offset:7888
    v_pk_mul_f32 v[66:67], v[60:61], v[54:55] op_sel_hi:[1,0]
    v_pk_fma_f32 v[60:61], v[60:61], v[54:55], v[66:67] op_sel:[1,1,0] op_sel_hi:[0,1,1] neg_lo:[0,1,0]
    v_cvt_pk_bf16_f32 v69, v60, v61
    ds_write_addtid_b32 v69 offset:8160
    v_pk_mul_f32 v[66:67], v[60:61], v[54:55] op_sel_hi:[1,0]
    v_pk_fma_f32 v[60:61], v[60:61], v[54:55], v[66:67] op_sel:[1,1,0] op_sel_hi:[0,1,1] neg_lo:[0,1,0]
    v_cvt_pk_bf16_f32 v69, v60, v61
    ds_write_addtid_b32 v69 offset:8432
    s_waitcnt lgkmcnt(0)
    ds_read_b128 v[72:75], v104 offset:8704
    ds_read_b128 v[88:91], v104 offset:0
    ds_read_b128 v[76:79], v104 offset:8736
    ds_read_b128 v[92:95], v104 offset:32
    ds_read_b128 v[80:83], v104 offset:8768
    ds_read_b128 v[96:99], v104 offset:64
    ds_read_b128 v[84:87], v104 offset:8800
    ds_read_b128 v[100:103], v104 offset:96
    s_waitcnt lgkmcnt(6)
    v_mfma_f32_32x32x16_bf16 v[32:47], v[72:75], v[88:91], v[32:47]
    ds_read_b128 v[72:75], v104 offset:8832
    ds_read_b128 v[88:91], v104 offset:128
    s_waitcnt lgkmcnt(6)
    v_mfma_f32_32x32x16_bf16 v[32:47], v[76:79], v[92:95], v[32:47]
    ds_read_b128 v[76:79], v104 offset:8864
    ds_read_b128 v[92:95], v104 offset:160
    s_waitcnt lgkmcnt(6)
    v_mfma_f32_32x32x16_bf16 v[32:47], v[80:83], v[96:99], v[32:47]
    ds_read_b128 v[80:83], v104 offset:8896
    ds_read_b128 v[96:99], v104 offset:192
    s_waitcnt lgkmcnt(6)
    v_mfma_f32_32x32x16_bf16 v[32:47], v[84:87], v[100:103], v[32:47]
    ds_read_b128 v[84:87], v104 offset:8928
    ds_read_b128 v[100:103], v104 offset:224
    s_waitcnt lgkmcnt(6)
    v_mfma_f32_32x32x16_bf16 v[32:47], v[72:75], v[88:91], v[32:47]
    s_waitcnt lgkmcnt(4)
    v_mfma_f32_32x32x16_bf16 v[32:47], v[76:79], v[92:95], v[32:47]
    s_waitcnt lgkmcnt(2)
    v_mfma_f32_32x32x16_bf16 v[32:47], v[80:83], v[96:99], v[32:47]
    s_waitcnt lgkmcnt(0)
    v_mfma_f32_32x32x16_bf16 v[32:47], v[84:87], v[100:103], v[32:47]
    s_waitcnt vmcnt(0)
    s_mov_b32 s60, 0
L_flBgate:
    v_cmp_ne_u32 vcc, 1, v29
    s_nop 0
    s_cmp_eq_u64 vcc, 0
    s_cbranch_scc1 L_flokBgate
    s_add_u32 s60, s60, 1
    s_cmp_gt_u32 s60, 30000
    s_cbranch_scc1 L_flokBgate
    s_setprio 3
    global_load_dword v29, v28, s[28:29] sc1
    s_setprio 0
    s_waitcnt vmcnt(0)
    s_branch L_flBgate
L_flokBgate:
    s_barrier
    s_cmp_eq_u32 s35, 0
    s_cbranch_scc0 L_B_nopub3
    s_lshl_b32 s39, s33, 7
    s_lshl_b32 s42, s34, 2
    s_add_u32 s39, s39, s42
    s_add_u32 s39, s39, 4096
    v_mov_b32 v2, s39
    v_mov_b32 v3, 1
    s_mov_b64 exec, 1
    s_setprio 3
    global_store_dword v2, v3, s[30:31] sc1
    s_setprio 0
    s_mov_b64 exec, -1
L_B_nopub3:
    v_and_b32 v2, 0xffff0000, v20
    v_and_b32 v3, 0xffff0000, v21
    v_and_b32 v4, 0xffff0000, v22
    v_and_b32 v5, 0xffff0000, v23
    v_mul_f32 v2, 0x3fb8aa3b, v2
    v_exp_f32 v2, v2
    v_mul_f32 v3, v3, v26
    v_cvt_pk_bf16_f32 v2, v2, v2
    v_lshlrev_b32 v2, 16, v2
    v_mul_f32 v2, v2, v26
    v_mul_f32 v71, 0x3e22f983, v3
    v_mul_f32 v70, 0xbfb8aa3b, v2
    v_mul_f32 v62, v4, v27
    v_mul_f32 v63, v5, v27
    v_exp_f32 v112, v70
    v_fract_f32 v113, v71
    v_cos_f32 v114, v113
    v_sin_f32 v115, v113
    v_mul_f32 v48, v112, v114
    v_mul_f32 v49, v112, v115
    v_mul_f32 v116, 0x41000000, v70
    v_mul_f32 v117, 0x41000000, v71
    v_exp_f32 v116, v116
    v_fract_f32 v117, v117
    v_cos_f32 v118, v117
    v_sin_f32 v119, v117
    v_mul_f32 v54, v116, v118
    v_mul_f32 v55, v116, v119
    v_mul_f32 v120, 0x43800000, v70
    v_mul_f32 v121, 0x43800000, v71
    v_exp_f32 v120, v120
    v_fract_f32 v121, v121
    v_cos_f32 v122, v121
    v_sin_f32 v123, v121
    v_mul_f32 v56, v120, v122
    v_mul_f32 v57, v120, v123
    v_pk_mul_f32 v[64:65], v[48:49], v[48:49] op_sel_hi:[1,0]
    v_pk_fma_f32 v[50:51], v[48:49], v[48:49], v[64:65] op_sel:[1,1,0] op_sel_hi:[0,1,1] neg_lo:[0,1,0]
    v_pk_mul_f32 v[64:65], v[50:51], v[50:51] op_sel_hi:[1,0]
    v_pk_fma_f32 v[52:53], v[50:51], v[50:51], v[64:65] op_sel:[1,1,0] op_sel_hi:[0,1,1] neg_lo:[0,1,0]
    v_cvt_pk_bf16_f32 v68, v62, -v63
    v_mov_b32 v69, 0x3f80
    ds_write_addtid_b32 v68 offset:8704
    ds_write_addtid_b32 v69 offset:0
    v_pk_mul_f32 v[64:65], v[62:63], v[48:49] op_sel_hi:[1,0]
    v_cvt_pk_bf16_f32 v69, v54, v55
    v_pk_fma_f32 v[58:59], v[62:63], v[48:49], v[64:65] op_sel:[1,1,0] op_sel_hi:[0,1,1] neg_lo:[0,1,0]
    ds_write_addtid_b32 v69 offset:272
    v_cvt_pk_bf16_f32 v68, v58, -v59
    ds_write_addtid_b32 v68 offset:8976
    v_pk_mul_f32 v[64:65], v[58:59], v[48:49] op_sel_hi:[1,0]
    v_pk_mul_f32 v[66:67], v[54:55], v[54:55] op_sel_hi:[1,0]
    v_pk_fma_f32 v[58:59], v[58:59], v[48:49], v[64:65] op_sel:[1,1,0] op_sel_hi:[0,1,1] neg_lo:[0,1,0]
    v_pk_fma_f32 v[60:61], v[54:55], v[54:55], v[66:67] op_sel:[1,1,0] op_sel_hi:[0,1,1] neg_lo:[0,1,0]
    v_cvt_pk_bf16_f32 v68, v58, -v59
    v_cvt_pk_bf16_f32 v69, v60, v61
    ds_write_addtid_b32 v68 offset:9248
    ds_write_addtid_b32 v69 offset:544
    v_pk_mul_f32 v[64:65], v[58:59], v[48:49] op_sel_hi:[1,0]
    v_pk_mul_f32 v[66:67], v[60:61], v[54:55] op_sel_hi:[1,0]
    v_pk_fma_f32 v[58:59], v[58:59], v[48:49], v[64:65] op_sel:[1,1,0] op_sel_hi:[0,1,1] neg_lo:[0,1,0]
    v_pk_fma_f32 v[60:61], v[60:61], v[54:55], v[66:67] op_sel:[1,1,0] op_sel_hi:[0,1,1] neg_lo:[0,1,0]
    v_cvt_pk_bf16_f32 v68, v58, -v59
    v_cvt_pk_bf16_f32 v69, v60, v61
    ds_write_addtid_b32 v68 offset:9520
    ds_write_addtid_b32 v69 offset:816
    v_pk_mul_f32 v[64:65], v[58:59], v[48:49] op_sel_hi:[1,0]
    v_pk_mul_f32 v[66:67], v[60:61], v[54:55] op_sel_hi:[1,0]
    v_pk_fma_f32 v[58:59], v[58:59], v[48:49], v[64:65] op_sel:[1,1,0] op_sel_hi:[0,1,1] neg_lo:[0,1,0]
    v_pk_fma_f32 v[60:61], v[60:61], v[54:55], v[66:67] op_sel:[1,1,0] op_sel_hi:[0,1,1] neg_lo:[0,1,0]
    v_cvt_pk_bf16_f32 v68, v58, -v59
    v_cvt_pk_bf16_f32 v69, v60, v61
    ds_write_addtid_b32 v68 offset:9792
    ds_write_addtid_b32 v69 offset:1088
    v_pk_mul_f32 v[64:65], v[58:59], v[48:49] op_sel_hi:[1,0]
    v_pk_mul_f32 v[66:67], v[60:61], v[54:55] op_sel_hi:[1,0]
    v_pk_fma_f32 v[58:59], v[58:59], v[48:49], v[64:65] op_sel:[1,1,0] op_sel_hi:[0,1,1] neg_lo:[0,1,0]
    v_pk_fma_f32 v[60:61], v[60:61], v[54:55], v[66:67] op_sel:[1,1,0] op_sel_hi:[0,1,1] neg_lo:[0,1,0]
    v_cvt_pk_bf16_f32 v68, v58, -v59
    v_cvt_pk_bf16_f32 v69, v60, v61
    ds_write_addtid_b32 v68 offset:10064
    ds_write_addtid_b32 v69 offset:1360
    v_pk_mul_f32 v[64:65], v[58:59], v[48:49] op_sel_hi:[1,0]
    v_pk_mul_f32 v[66:67], v[60:61], v[54:55] op_sel_hi:[1,0]
    v_pk_fma_f32 v[58:59], v[58:59], v[48:49], v[64:65] op_sel:[1,1,0] op_sel_hi:[0,1,1] neg_lo:[0,1,0]
    v_pk_fma_f32 v[60:61], v[60:61], v[54:55], v[66:67] op_sel:[1,1,0] op_sel_hi:[0,1,1] neg_lo:[0,1,0]
    v_cvt_pk_bf16_f32 v68, v58, -v59
    v_cvt_pk_bf16_f32 v69, v60, v61
    ds_write_addtid_b32 v68 offset:10336
    ds_write_addtid_b32 v69 offset:1632
    v_pk_mul_f32 v[64:65], v[58:59], v[48:49] op_sel_hi:[1,0]
    v_pk_mul_f32 v[66:67], v[60:61], v[54:55] op_sel_hi:[1,0]
    v_pk_fma_f32 v[58:59], v[58:59], v[48:49], v[64:65] op_sel:[1,1,0] op_sel_hi:[0,1,1] neg_lo:[0,1,0]
    v_pk_fma_f32 v[60:61], v[60:61], v[54:55], v[66:67] op_sel:[1,1,0] op_sel_hi:[0,1,1] neg_lo:[0,1,0]
    v_cvt_pk_bf16_f32 v68, v58, -v59
    v_cvt_pk_bf16_f32 v69, v60, v61
    ds_write_addtid_b32 v68 offset:10608
    ds_write_addtid_b32 v69 offset:1904
    v_pk_mul_f32 v[64:65], v[62:63], v[56:57] op_sel_hi:[1,0]
    v_pk_mul_f32 v[66:67], v[60:61], v[54:55] op_sel_hi:[1,0]
    v_pk_fma_f32 v[62:63], v[62:63], v[56:57], v[64:65] op_sel:[1,1,0] op_sel_hi:[0,1,1] neg_lo:[0,1,0]
    v_pk_fma_f32 v[60:61], v[60:61], v[54:55], v[66:67] op_sel:[1,1,0] op_sel_hi:[0,1,1] neg_lo:[0,1,0]
    v_cvt_pk_bf16_f32 v68, v62, -v63
    v_cvt_pk_bf16_f32 v69, v60, v61
    ds_write_addtid_b32 v68 offset:10880
    ds_write_addtid_b32 v69 offset:2176
    ds_write_addtid_b32 v68 offset:11152
    v_pk_mul_f32 v[64:65], v[62:63], v[50:51] op_sel_hi:[1,0]
    v_pk_mul_f32 v[66:67], v[60:61], v[54:55] op_sel_hi:[1,0]
    v_pk_fma_f32 v[58:59], v[62:63], v[50:51], v[64:65] op_sel:[1,1,0] op_sel_hi:[0,1,1] neg_lo:[0,1,0]
    v_pk_fma_f32 v[60:61], v[60:61], v[54:55], v[66:67] op_sel:[1,1,0] op_sel_hi:[0,1,1] neg_lo:[0,1,0]
    v_cvt_pk_bf16_f32 v68, v58, -v59
    v_cvt_pk_bf16_f32 v69, v60, v61
    ds_write_addtid_b32 v68 offset:11424
    ds_write_addtid_b32 v69 offset:2448
    v_pk_mul_f32 v[64:65], v[58:59], v[50:51] op_sel_hi:[1,0]
    v_pk_mul_f32 v[66:67], v[60:61], v[54:55] op_sel_hi:[1,0]
    v_pk_fma_f32 v[58:59], v[58:59], v[50:51], v[64:65] op_sel:[1,1,0] op_sel_hi:[0,1,1] neg_lo:[0,1,0]
    v_pk_fma_f32 v[60:61], v[60:61], v[54:55], v[66:67] op_sel:[1,1,0] op_sel_hi:[0,1,1] neg_lo:[0,1,0]
    v_cvt_pk_bf16_f32 v68, v58, -v59
    v_cvt_pk_bf16_f32 v69, v60, v61
    ds_write_addtid_b32 v68 offset:11696
    ds_write_addtid_b32 v69 offset:2720
    ds_write_addtid_b32 v68 offset:11968
    ds_write_addtid_b32 v68 offset:12240
    v_pk_mul_f32 v[64:65], v[58:59], v[50:51] op_sel_hi:[1,0]
    v_pk_mul_f32 v[66:67], v[60:61], v[54:55] op_sel_hi:[1,0]
    v_pk_fma_f32 v[58:59], v[58:59], v[50:51], v[64:65] op_sel:[1,1,0] op_sel_hi:[0,1,1] neg_lo:[0,1,0]
    v_pk_fma_f32 v[60:61], v[60:61], v[54:55], v[66:67] op_sel:[1,1,0] op_sel_hi:[0,1,1] neg_lo:[0,1,0]
    v_cvt_pk_bf16_f32 v68, v58, -v59
    v_cvt_pk_bf16_f32 v69, v60, v61
    ds_write_addtid_b32 v68 offset:12512
    ds_write_addtid_b32 v69 offset:2992
    v_pk_mul_f32 v[64:65], v[58:59], v[50:51] op_sel_hi:[1,0]
    v_pk_mul_f32 v[66:67], v[60:61], v[54:55] op_sel_hi:[1,0]
    v_pk_fma_f32 v[58:59], v[58:59], v[50:51], v[64:65] op_sel:[1,1,0] op_sel_hi:[0,1,1] neg_lo:[0,1,0]
    v_pk_fma_f32 v[60:61], v[60:61], v[54:55], v[66:67] op_sel:[1,1,0] op_sel_hi:[0,1,1] neg_lo:[0,1,0]
    v_cvt_pk_bf16_f32 v68, v58, -v59
    v_cvt_pk_bf16_f32 v69, v60, v61
    ds_write_addtid_b32 v68 offset:12784
    ds_write_addtid_b32 v69 offset:3264
    v_pk_mul_f32 v[64:65], v[62:63], v[56:57] op_sel_hi:[1,0]
    v_pk_mul_f32 v[66:67], v[60:61], v[54:55] op_sel_hi:[1,0]
    v_pk_fma_f32 v[62:63], v[62:63], v[56:57], v[64:65] op_sel:[1,1,0] op_sel_hi:[0,1,1] neg_lo:[0,1,0]
    v_pk_fma_f32 v[60:61], v[60:61], v[54:55], v[66:67] op_sel:[1,1,0] op_sel_hi:[0,1,1] neg_lo:[0,1,0]
    v_cvt_pk_bf16_f32 v68, v62, -v63
    v_cvt_pk_bf16_f32 v69, v60, v61
    ds_write_addtid_b32 v68 offset:13056
    ds_write_addtid_b32 v69 offset:3536
    v_pk_mul_f32 v[64:65], v[62:63], v[52:53] op_sel_hi:[1,0]
    v_pk_mul_f32 v[66:67], v[60:61], v[54:55] op_sel_hi:[1,0]
    v_pk_fma_f32 v[58:59], v[62:63], v[52:53], v[64:65] op_sel:[1,1,0] op_sel_hi:[0,1,1] neg_lo:[0,1,0]
    v_pk_fma_f32 v[60:61], v[60:61], v[54:55], v[66:67] op_sel:[1,1,0] op_sel_hi:[0,1,1] neg_lo:[0,1,0]
    v_cvt_pk_bf16_f32 v68, v58, -v59
    v_cvt_pk_bf16_f32 v69, v60, v61
    ds_write_addtid_b32 v68 offset:13328
    ds_write_addtid_b32 v69 offset:3808
    v_pk_mul_f32 v[64:65], v[58:59], v[52:53] op_sel_hi:[1,0]
    v_pk_mul_f32 v[66:67], v[60:61], v[54:55] op_sel_hi:[1,0]
    v_pk_fma_f32 v[58:59], v[58:59], v[52:53], v[64:65] op_sel:[1,1,0] op_sel_hi:[0,1,1] neg_lo:[0,1,0]
    v_pk_fma_f32 v[60:61], v[60:61], v[54:55], v[66:67] op_sel:[1,1,0] op_sel_hi:[0,1,1] neg_lo:[0,1,0]
    v_cvt_pk_bf16_f32 v68, v58, -v59
    v_cvt_pk_bf16_f32 v69, v60, v61
    ds_write_addtid_b32 v68 offset:13600
    ds_write_addtid_b32 v69 offset:4080
    v_pk_mul_f32 v[64:65], v[62:63], v[56:57] op_sel_hi:[1,0]
    v_pk_mul_f32 v[66:67], v[60:61], v[54:55] op_sel_hi:[1,0]
    v_pk_fma_f32 v[62:63], v[62:63], v[56:57], v[64:65] op_sel:[1,1,0] op_sel_hi:[0,1,1] neg_lo:[0,1,0]
    v_pk_fma_f32 v[60:61], v[60:61], v[54:55], v[66:67] op_sel:[1,1,0] op_sel_hi:[0,1,1] neg_lo:[0,1,0]
    v_cvt_pk_bf16_f32 v68, v62, -v63
    v_cvt_pk_bf16_f32 v69, v60, v61
    ds_write_addtid_b32 v68 offset:14144
    ds_write_addtid_b32 v69 offset:4352
    v_pk_mul_f32 v[64:65], v[62:63], v[52:53] op_sel_hi:[1,0]
    v_pk_mul_f32 v[66:67], v[60:61], v[54:55] op_sel_hi:[1,0]
    v_pk_fma_f32 v[58:59], v[62:63], v[52:53], v[64:65] op_sel:[1,1,0] op_sel_hi:[0,1,1] neg_lo:[0,1,0]
    v_pk_fma_f32 v[60:61], v[60:61], v[54:55], v[66:67] op_sel:[1,1,0] op_sel_hi:[0,1,1] neg_lo:[0,1,0]
    v_cvt_pk_bf16_f32 v68, v58, -v59
    v_cvt_pk_bf16_f32 v69, v60, v61
    ds_write_addtid_b32 v68 offset:14416
    ds_write_addtid_b32 v69 offset:4624
    v_pk_mul_f32 v[64:65], v[58:59], v[52:53] op_sel_hi:[1,0]
    v_pk_mul_f32 v[66:67], v[60:61], v[54:55] op_sel_hi:[1,0]
    v_pk_fma_f32 v[58:59], v[58:59], v[52:53], v[64:65] op_sel:[1,1,0] op_sel_hi:[0,1,1] neg_lo:[0,1,0]
    v_pk_fma_f32 v[60:61], v[60:61], v[54:55], v[66:67] op_sel:[1,1,0] op_sel_hi:[0,1,1] neg_lo:[0,1,0]
    v_cvt_pk_bf16_f32 v68, v58, -v59
    v_cvt_pk_bf16_f32 v69, v60, v61
    ds_write_addtid_b32 v68 offset:14688
    ds_write_addtid_b32 v69 offset:4896
    v_pk_mul_f32 v[64:65], v[62:63], v[56:57] op_sel_hi:[1,0]
    v_pk_mul_f32 v[66:67], v[60:61], v[54:55] op_sel_hi:[1,0]
    v_pk_fma_f32 v[62:63], v[62:63], v[56:57], v[64:65] op_sel:[1,1,0] op_sel_hi:[0,1,1] neg_lo:[0,1,0]
    v_pk_fma_f32 v[60:61], v[60:61], v[54:55], v[66:67] op_sel:[1,1,0] op_sel_hi:[0,1,1] neg_lo:[0,1,0]
    v_cvt_pk_bf16_f32 v68, v62, -v63
    v_cvt_pk_bf16_f32 v69, v60, v61
    ds_write_addtid_b32 v68 offset:15232
    ds_write_addtid_b32 v69 offset:5168
    v_pk_mul_f32 v[64:65], v[62:63], v[54:55] op_sel_hi:[1,0]
    v_pk_mul_f32 v[66:67], v[60:61], v[54:55] op_sel_hi:[1,0]
    v_pk_fma_f32 v[58:59], v[62:63], v[54:55], v[64:65] op_sel:[1,1,0] op_sel_hi:[0,1,1] neg_lo:[0,1,0]
    v_pk_fma_f32 v[60:61], v[60:61], v[54:55], v[66:67] op_sel:[1,1,0] op_sel_hi:[0,1,1] neg_lo:[0,1,0]
    v_cvt_pk_bf16_f32 v68, v58, -v59
    v_cvt_pk_bf16_f32 v69, v60, v61
    ds_write_addtid_b32 v68 offset:15504
    ds_write_addtid_b32 v69 offset:5440
    v_pk_mul_f32 v[64:65], v[62:63], v[56:57] op_sel_hi:[1,0]
    v_pk_mul_f32 v[66:67], v[60:61], v[54:55] op_sel_hi:[1,0]
    v_pk_fma_f32 v[62:63], v[62:63], v[56:57], v[64:65] op_sel:[1,1,0] op_sel_hi:[0,1,1] neg_lo:[0,1,0]
    v_pk_fma_f32 v[60:61], v[60:61], v[54:55], v[66:67] op_sel:[1,1,0] op_sel_hi:[0,1,1] neg_lo:[0,1,0]
    v_cvt_pk_bf16_f32 v68, v62, -v63
    v_cvt_pk_bf16_f32 v69, v60, v61
    ds_write_addtid_b32 v68 offset:15776
    ds_write_addtid_b32 v69 offset:5712
    v_pk_mul_f32 v[64:65], v[62:63], v[54:55] op_sel_hi:[1,0]
    v_pk_mul_f32 v[66:67], v[60:61], v[54:55] op_sel_hi:[1,0]
    v_pk_fma_f32 v[58:59], v[62:63], v[54:55], v[64:65] op_sel:[1,1,0] op_sel_hi:[0,1,1] neg_lo:[0,1,0]
    v_pk_fma_f32 v[60:61], v[60:61], v[54:55], v[66:67] op_sel:[1,1,0] op_sel_hi:[0,1,1] neg_lo:[0,1,0]
    v_cvt_pk_bf16_f32 v68, v58, -v59
    v_cvt_pk_bf16_f32 v69, v60, v61
    ds_write_addtid_b32 v68 offset:16048
    ds_write_addtid_b32 v69 offset:5984
    v_pk_mul_f32 v[64:65], v[62:63], v[56:57] op_sel_hi:[1,0]
    v_pk_mul_f32 v[66:67], v[60:61], v[54:55] op_sel_hi:[1,0]
    v_pk_fma_f32 v[62:63], v[62:63], v[56:57], v[64:65] op_sel:[1,1,0] op_sel_hi:[0,1,1] neg_lo:[0,1,0]
    v_pk_fma_f32 v[60:61], v[60:61], v[54:55], v[66:67] op_sel:[1,1,0] op_sel_hi:[0,1,1] neg_lo:[0,1,0]
    v_cvt_pk_bf16_f32 v68, v62, -v63
    v_cvt_pk_bf16_f32 v69, v60, v61
    ds_write_addtid_b32 v68 offset:16320
    ds_write_addtid_b32 v69 offset:6256
    v_pk_mul_f32 v[64:65], v[62:63], v[54:55] op_sel_hi:[1,0]
    v_pk_mul_f32 v[66:67], v[60:61], v[54:55] op_sel_hi:[1,0]
    v_pk_fma_f32 v[58:59], v[62:63], v[54:55], v[64:65] op_sel:[1,1,0] op_sel_hi:[0,1,1] neg_lo:[0,1,0]
    v_pk_fma_f32 v[60:61], v[60:61], v[54:55], v[66:67] op_sel:[1,1,0] op_sel_hi:[0,1,1] neg_lo:[0,1,0]
    v_cvt_pk_bf16_f32 v68, v58, -v59
    v_cvt_pk_bf16_f32 v69, v60, v61
    ds_write_addtid_b32 v68 offset:16592
    ds_write_addtid_b32 v69 offset:6528
    v_pk_mul_f32 v[64:65], v[62:63], v[56:57] op_sel_hi:[1,0]
    v_pk_mul_f32 v[66:67], v[60:61], v[54:55] op_sel_hi:[1,0]
    v_pk_fma_f32 v[62:63], v[62:63], v[56:57], v[64:65] op_sel:[1,1,0] op_sel_hi:[0,1,1] neg_lo:[0,1,0]
    v_pk_fma_f32 v[60:61], v[60:61], v[54:55], v[66:67] op_sel:[1,1,0] op_sel_hi:[0,1,1] neg_lo:[0,1,0]
    v_cvt_pk_bf16_f32 v68, v62, -v63
    v_cvt_pk_bf16_f32 v69, v60, v61
    ds_write_addtid_b32 v68 offset:16864
    ds_write_addtid_b32 v69 offset:6800
    s_lshl_b32 s39, s33, 7
    s_add_u32 s39, s39, 4096
    v_and_b32 v28, 31, v1
    v_lshl_add_u32 v28, v28, 2, s39
    s_setprio 3
    global_load_dword v29, v28, s[30:31] sc1
    s_setprio 0
    v_pk_mul_f32 v[64:65], v[62:63], v[54:55] op_sel_hi:[1,0]
    v_pk_mul_f32 v[66:67], v[60:61], v[54:55] op_sel_hi:[1,0]
    v_pk_fma_f32 v[58:59], v[62:63], v[54:55], v[64:65] op_sel:[1,1,0] op_sel_hi:[0,1,1] neg_lo:[0,1,0]
    v_pk_fma_f32 v[60:61], v[60:61], v[54:55], v[66:67] op_sel:[1,1,0] op_sel_hi:[0,1,1] neg_lo:[0,1,0]
    v_cvt_pk_bf16_f32 v68, v58, -v59
    v_cvt_pk_bf16_f32 v69, v60, v61
    ds_write_addtid_b32 v68 offset:17136
    ds_write_addtid_b32 v69 offset:7072
    v_pk_mul_f32 v[66:67], v[60:61], v[54:55] op_sel_hi:[1,0]
    v_pk_fma_f32 v[60:61], v[60:61], v[54:55], v[66:67] op_sel:[1,1,0] op_sel_hi:[0,1,1] neg_lo:[0,1,0]
    v_cvt_pk_bf16_f32 v69, v60, v61
    ds_write_addtid_b32 v69 offset:7344
    v_pk_mul_f32 v[66:67], v[60:61], v[54:55] op_sel_hi:[1,0]
    v_pk_fma_f32 v[60:61], v[60:61], v[54:55], v[66:67] op_sel:[1,1,0] op_sel_hi:[0,1,1] neg_lo:[0,1,0]
    v_cvt_pk_bf16_f32 v69, v60, v61
    ds_write_addtid_b32 v69 offset:7616
    v_pk_mul_f32 v[66:67], v[60:61], v[54:55] op_sel_hi:[1,0]
    v_pk_fma_f32 v[60:61], v[60:61], v[54:55], v[66:67] op_sel:[1,1,0] op_sel_hi:[0,1,1] neg_lo:[0,1,0]
    v_cvt_pk_bf16_f32 v69, v60, v61
    ds_write_addtid_b32 v69 offset:7888
    v_pk_mul_f32 v[66:67], v[60:61], v[54:55] op_sel_hi:[1,0]
    v_pk_fma_f32 v[60:61], v[60:61], v[54:55], v[66:67] op_sel:[1,1,0] op_sel_hi:[0,1,1] neg_lo:[0,1,0]
    v_cvt_pk_bf16_f32 v69, v60, v61
    ds_write_addtid_b32 v69 offset:8160
    v_pk_mul_f32 v[66:67], v[60:61], v[54:55] op_sel_hi:[1,0]
    v_pk_fma_f32 v[60:61], v[60:61], v[54:55], v[66:67] op_sel:[1,1,0] op_sel_hi:[0,1,1] neg_lo:[0,1,0]
    v_cvt_pk_bf16_f32 v69, v60, v61
    ds_write_addtid_b32 v69 offset:8432
    s_waitcnt lgkmcnt(0)
    ds_read_b128 v[72:75], v104 offset:8704
    ds_read_b128 v[88:91], v104 offset:0
    ds_read_b128 v[76:79], v104 offset:8736
    ds_read_b128 v[92:95], v104 offset:32
    ds_read_b128 v[80:83], v104 offset:8768
    ds_read_b128 v[96:99], v104 offset:64
    ds_read_b128 v[84:87], v104 offset:8800
    ds_read_b128 v[100:103], v104 offset:96
    s_waitcnt lgkmcnt(6)
    v_mfma_f32_32x32x16_bf16 v[32:47], v[72:75], v[88:91], v[32:47]
    ds_read_b128 v[72:75], v104 offset:8832
    ds_read_b128 v[88:91], v104 offset:128
    s_waitcnt lgkmcnt(6)
    v_mfma_f32_32x32x16_bf16 v[32:47], v[76:79], v[92:95], v[32:47]
    ds_read_b128 v[76:79], v104 offset:8864
    ds_read_b128 v[92:95], v104 offset:160
    s_waitcnt lgkmcnt(6)
    v_mfma_f32_32x32x16_bf16 v[32:47], v[80:83], v[96:99], v[32:47]
    ds_read_b128 v[80:83], v104 offset:8896
    ds_read_b128 v[96:99], v104 offset:192
    s_waitcnt lgkmcnt(6)
    v_mfma_f32_32x32x16_bf16 v[32:47], v[84:87], v[100:103], v[32:47]
    ds_read_b128 v[84:87], v104 offset:8928
    ds_read_b128 v[100:103], v104 offset:224
    s_waitcnt lgkmcnt(6)
    v_mfma_f32_32x32x16_bf16 v[32:47], v[72:75], v[88:91], v[32:47]
    s_waitcnt lgkmcnt(4)
    v_mfma_f32_32x32x16_bf16 v[32:47], v[76:79], v[92:95], v[32:47]
    s_waitcnt lgkmcnt(2)
    v_mfma_f32_32x32x16_bf16 v[32:47], v[80:83], v[96:99], v[32:47]
    s_waitcnt lgkmcnt(0)
    v_mfma_f32_32x32x16_bf16 v[32:47], v[84:87], v[100:103], v[32:47]
    s_waitcnt vmcnt(0)
    s_mov_b32 s60, 0
L_flB3:
    v_cmp_ne_u32 vcc, 1, v29
    s_nop 0
    s_cmp_eq_u64 vcc, 0
    s_cbranch_scc1 L_flokB3
    s_add_u32 s60, s60, 1
    s_cmp_gt_u32 s60, 30000
    s_cbranch_scc1 L_flokB3
    s_setprio 3
    global_load_dword v29, v28, s[30:31] sc1
    s_setprio 0
    s_waitcnt vmcnt(0)
    s_branch L_flB3
L_flokB3:
    s_lshl_b32 s39, s32, 13
    s_add_u32 s39, s39, 6291456
    v_lshl_add_u32 v6, v0, 4, s39
    v_add_u32 v7, 4096, v6
    s_setprio 3
    global_load_dwordx4 v[12:15], v6, s[30:31] sc1
    global_load_dwordx4 v[16:19], v7, s[30:31] sc1
    s_setprio 0
    s_mul_i32 s39, s35, 17408
    v_lshl_add_u32 v2, v1, 4, s39
    s_xor_b32 s42, s35, 1
    s_mul_i32 s42, s42, 17408
    v_lshl_add_u32 v3, v1, 4, s42
    s_cmp_eq_u32 s36, 0
    s_cbranch_scc0 L_B_snd1
    ds_write_b128 v2, v[40:43]
    ds_write_b128 v2, v[44:47] offset:1024
    s_branch L_B_snd2
L_B_snd1:
    ds_write_b128 v2, v[32:35]
    ds_write_b128 v2, v[36:39] offset:1024
L_B_snd2:
    s_waitcnt lgkmcnt(0)
    s_barrier
    ds_read_b128 v[72:75], v3
    ds_read_b128 v[76:79], v3 offset:1024
    v_lshlrev_b32 v8, 4, v0
    v_add_u32 v8, 70112, v8
    s_mul_i32 s44, s37, 16640
    v_and_b32 v9, 31, v1
    v_lshrrev_b32 v10, 5, v1
    s_waitcnt lgkmcnt(0)
    s_barrier
    s_cmp_eq_u32 s36, 0
    s_cbranch_scc0 L_B_exp1
    v_add_f32 v72, v72, v32
    v_add_f32 v73, v73, v33
    v_add_f32 v74, v74, v34
    v_add_f32 v75, v75, v35
    v_add_f32 v76, v76, v36
    v_add_f32 v77, v77, v37
    v_add_f32 v78, v78, v38
    v_add_f32 v79, v79, v39
    v_lshlrev_b32 v2, 4, v9
    v_lshl_add_u32 v2, v10, 3, v2
    v_sub_u32 v2, 4088, v2
    v_add_u32 v2, s44, v2
    v_cvt_pk_bf16_f32 v80, v75, v74
    v_cvt_pk_bf16_f32 v81, v73, v72
    v_cvt_pk_bf16_f32 v82, v79, v78
    v_cvt_pk_bf16_f32 v83, v77, v76
    v_add_u32 v3, 4294966784, v2
    ds_write_b64 v2, v[80:81]
    ds_write_b64 v3, v[82:83]
    v_lshrrev_b32 v4, 2, v1
    v_mul_u32_u24 v4, 4160, v4
    v_and_b32 v5, 3, v1
    v_lshl_add_u32 v4, v5, 4, v4
    v_add_u32 v4, s44, v4
    v_mov_b32 v84, 0
    v_mov_b32 v85, 0
    v_mov_b32 v86, 0
    v_mov_b32 v87, 0
    s_mov_b64 exec, 0xffff
    ds_write_b128 v4, v[84:87] offset:4096
    s_mov_b64 exec, -1
    s_mul_i32 s39, s37, 4608
    s_add_u32 s39, s39, 69632
    v_lshl_add_u32 v4, v1, 4, s39
    s_mov_b64 exec, 0x3fffffff
    ds_write_b128 v4, v[84:87]
    s_mov_b64 exec, -1
    s_branch L_B_exp2
L_B_exp1:
    v_add_f32 v72, v72, v40
    v_add_f32 v73, v73, v41
    v_add_f32 v74, v74, v42
    v_add_f32 v75, v75, v43
    v_add_f32 v76, v76, v44
    v_add_f32 v77, v77, v45
    v_add_f32 v78, v78, v46
    v_add_f32 v79, v79, v47
    v_lshlrev_b32 v2, 4, v9
    v_lshl_add_u32 v2, v10, 9, v2
    v_sub_u32 v2, 3056, v2
    v_add_u32 v2, s44, v2
    v_cvt_pk_bf16_f32 v80, v74, v74
    v_cvt_pk_bf16_f32 v81, v73, v73
    v_cvt_pk_bf16_f32 v82, v73, v72
    v_cvt_pk_bf16_f32 v83, v72, v72
    ds_write_b128 v2, v[80:83]
    v_lshlrev_b32 v3, 4, v9
    v_lshl_add_u32 v3, v10, 10, v3
    v_sub_u32 v3, 2032, v3
    v_add_u32 v3, s44, v3
    v_add_u32 v4, 4294966784, v3
    s_mov_b32 s46, 0xaaaaaaaa
    s_mov_b32 s47, 0xaaaaaaaa
    v_cndmask_b32_e64 v5, v76, v77, s[46:47]
    v_cndmask_b32_e64 v6, v78, v79, s[46:47]
    v_cvt_pk_bf16_f32 v84, v77, v77
    v_cvt_pk_bf16_f32 v85, v77, v5
    v_cvt_pk_bf16_f32 v86, v76, v76
    v_cvt_pk_bf16_f32 v87, v76, v76
    v_cvt_pk_bf16_f32 v88, v79, v79
    v_cvt_pk_bf16_f32 v89, v79, v6
    v_cvt_pk_bf16_f32 v90, v78, v78
    v_cvt_pk_bf16_f32 v91, v78, v78
    ds_write_b128 v3, v[84:87]
    ds_write_b128 v4, v[88:91]
L_B_exp2:
    s_waitcnt vmcnt(0)
    ds_write_b128 v8, v[12:15]
    ds_write_b128 v8, v[16:19] offset:4608
    s_waitcnt lgkmcnt(0)
    s_barrier
    s_lshl_b32 s39, s36, 11
    s_add_u32 s39, s39, s44
    v_lshl_add_u32 v2, v1, 4, s39
    ds_read_b128 v[72:75], v2
    ds_read_b64 v[76:77], v2 offset:16
    ds_read_b128 v[80:83], v2 offset:1024
    ds_read_b64 v[84:85], v2 offset:1040
    s_waitcnt lgkmcnt(2)
    v_alignbit_b32 v88, v73, v72, 16
    v_alignbit_b32 v89, v74, v73, 16
    v_alignbit_b32 v90, v75, v74, 16
    v_alignbit_b32 v91, v76, v75, 16
    v_mov_b32 v92, v73
    v_mov_b32 v93, v74
    v_mov_b32 v94, v75
    v_mov_b32 v95, v76
    v_alignbit_b32 v96, v74, v73, 16
    v_alignbit_b32 v97, v75, v74, 16
    v_alignbit_b32 v98, v76, v75, 16
    v_alignbit_b32 v99, v77, v76, 16
    ds_write_b128 v2, v[88:91] offset:4160
    ds_write_b128 v2, v[92:95] offset:8320
    ds_write_b128 v2, v[96:99] offset:12480
    s_waitcnt lgkmcnt(3)
    v_alignbit_b32 v100, v81, v80, 16
    v_alignbit_b32 v101, v82, v81, 16
    v_alignbit_b32 v102, v83, v82, 16
    v_alignbit_b32 v103, v84, v83, 16
    v_mov_b32 v104, v81
    v_mov_b32 v105, v82
    v_mov_b32 v106, v83
    v_mov_b32 v107, v84
    v_alignbit_b32 v108, v82, v81, 16
    v_alignbit_b32 v109, v83, v82, 16
    v_alignbit_b32 v110, v84, v83, 16
    v_alignbit_b32 v111, v85, v84, 16
    ds_write_b128 v2, v[100:103] offset:5184
    ds_write_b128 v2, v[104:107] offset:9344
    ds_write_b128 v2, v[108:111] offset:13504
    v_and_b32 v2, 15, v1
    v_lshrrev_b32 v3, 4, v1
    v_sub_u32 v4, 3, v2
    v_and_b32 v4, 3, v4
    v_lshlrev_b32 v5, 3, v3
    v_sub_u32 v5, v5, v2
    v_add_u32 v5, 15, v5
    v_sub_u32 v5, v5, v4
    v_lshlrev_b32 v5, 1, v5
    v_mul_u32_u24 v4, 4160, v4
    v_add_u32 v5, v5, v4
    s_lshl_b32 s39, s36, 8
    s_add_u32 s42, s39, s44
    v_add_u32 v192, s42, v5
    v_lshlrev_b32 v5, 5, v2
    v_lshl_add_u32 v5, v3, 4, v5
    s_mul_i32 s42, s37, 4608
    s_add_u32 s42, s42, 69632
    s_add_u32 s39, s39, s42
    v_add_u32 v193, s39, v5
    s_waitcnt lgkmcnt(0)
    s_barrier
    ds_read_b128 v[128:131], v193 offset:0
    ds_read_b64 v[64:65], v192 offset:3584
    ds_read_b64 v[66:67], v192 offset:3592
    ds_read_b128 v[132:135], v193 offset:512
    ds_read_b64 v[68:69], v192 offset:3072
    ds_read_b64 v[70:71], v192 offset:3080
    ds_read_b128 v[136:139], v193 offset:1024
    ds_read_b64 v[72:73], v192 offset:2560
    ds_read_b64 v[74:75], v192 offset:2568
    ds_read_b128 v[140:143], v193 offset:1536
    ds_read_b64 v[76:77], v192 offset:2048
    ds_read_b64 v[78:79], v192 offset:2056
    s_waitcnt lgkmcnt(0)
    ds_read_b128 v[144:147], v193 offset:2048
    ds_read_b64 v[80:81], v192 offset:1536
    ds_read_b64 v[82:83], v192 offset:1544
    ds_read_b128 v[148:151], v193 offset:2560
    ds_read_b64 v[84:85], v192 offset:1024
    ds_read_b64 v[86:87], v192 offset:1032
    ds_read_b128 v[152:155], v193 offset:3072
    ds_read_b64 v[88:89], v192 offset:512
    ds_read_b64 v[90:91], v192 offset:520
    ds_read_b128 v[156:159], v193 offset:3584
    ds_read_b64 v[92:93], v192 offset:0
    ds_read_b64 v[94:95], v192 offset:8
    s_waitcnt lgkmcnt(0)
    s_waitcnt lgkmcnt(0)
    v_mfma_f32_16x16x32_bf16 v[32:35], v[64:67], v[128:131], 0
    ds_read_b128 v[160:163], v193 offset:64
    v_mfma_f32_16x16x32_bf16 v[36:39], v[68:71], v[128:131], 0
    ds_read_b64 v[96:97], v192 offset:3648
    v_mfma_f32_16x16x32_bf16 v[40:43], v[72:75], v[128:131], 0
    ds_read_b64 v[98:99], v192 offset:3656
    v_mfma_f32_16x16x32_bf16 v[44:47], v[76:79], v[128:131], 0
    ds_read_b128 v[164:167], v193 offset:576
    v_mfma_f32_16x16x32_bf16 v[48:51], v[80:83], v[128:131], 0
    ds_read_b64 v[100:101], v192 offset:3136
    v_mfma_f32_16x16x32_bf16 v[52:55], v[84:87], v[128:131], 0
    ds_read_b64 v[102:103], v192 offset:3144
    v_mfma_f32_16x16x32_bf16 v[56:59], v[88:91], v[128:131], 0
    ds_read_b128 v[168:171], v193 offset:1088
    v_mfma_f32_16x16x32_bf16 v[60:63], v[92:95], v[128:131], 0
    ds_read_b64 v[104:105], v192 offset:2624
    v_mfma_f32_16x16x32_bf16 v[36:39], v[64:67], v[132:135], v[36:39]
    ds_read_b64 v[106:107], v192 offset:2632
    v_mfma_f32_16x16x32_bf16 v[40:43], v[68:71], v[132:135], v[40:43]
    ds_read_b128 v[172:175], v193 offset:1600
    v_mfma_f32_16x16x32_bf16 v[44:47], v[72:75], v[132:135], v[44:47]
    ds_read_b64 v[108:109], v192 offset:2112
    v_mfma_f32_16x16x32_bf16 v[48:51], v[76:79], v[132:135], v[48:51]
    ds_read_b64 v[110:111], v192 offset:2120
    v_mfma_f32_16x16x32_bf16 v[52:55], v[80:83], v[132:135], v[52:55]
    ds_read_b128 v[176:179], v193 offset:2112
    v_mfma_f32_16x16x32_bf16 v[56:59], v[84:87], v[132:135], v[56:59]
    ds_read_b64 v[112:113], v192 offset:1600
    v_mfma_f32_16x16x32_bf16 v[60:63], v[88:91], v[132:135], v[60:63]
    ds_read_b64 v[114:115], v192 offset:1608
    v_mfma_f32_16x16x32_bf16 v[40:43], v[64:67], v[136:139], v[40:43]
    ds_read_b128 v[180:183], v193 offset:2624
    v_mfma_f32_16x16x32_bf16 v[44:47], v[68:71], v[136:139], v[44:47]
    ds_read_b64 v[116:117], v192 offset:1088
    v_mfma_f32_16x16x32_bf16 v[48:51], v[72:75], v[136:139], v[48:51]
    ds_read_b64 v[118:119], v192 offset:1096
    v_mfma_f32_16x16x32_bf16 v[52:55], v[76:79], v[136:139], v[52:55]
    ds_read_b128 v[184:187], v193 offset:3136
    v_mfma_f32_16x16x32_bf16 v[56:59], v[80:83], v[136:139], v[56:59]
    ds_read_b64 v[120:121], v192 offset:576
    v_mfma_f32_16x16x32_bf16 v[60:63], v[84:87], v[136:139], v[60:63]
    ds_read_b64 v[122:123], v192 offset:584
    v_mfma_f32_16x16x32_bf16 v[44:47], v[64:67], v[140:143], v[44:47]
    ds_read_b128 v[188:191], v193 offset:3648
    v_mfma_f32_16x16x32_bf16 v[48:51], v[68:71], v[140:143], v[48:51]
    ds_read_b64 v[124:125], v192 offset:64
    v_mfma_f32_16x16x32_bf16 v[52:55], v[72:75], v[140:143], v[52:55]
    ds_read_b64 v[126:127], v192 offset:72
    v_mfma_f32_16x16x32_bf16 v[56:59], v[76:79], v[140:143], v[56:59]
    v_mfma_f32_16x16x32_bf16 v[60:63], v[80:83], v[140:143], v[60:63]
    v_mfma_f32_16x16x32_bf16 v[48:51], v[64:67], v[144:147], v[48:51]
    v_mfma_f32_16x16x32_bf16 v[52:55], v[68:71], v[144:147], v[52:55]
    v_mfma_f32_16x16x32_bf16 v[56:59], v[72:75], v[144:147], v[56:59]
    v_mfma_f32_16x16x32_bf16 v[60:63], v[76:79], v[144:147], v[60:63]
    v_mfma_f32_16x16x32_bf16 v[52:55], v[64:67], v[148:151], v[52:55]
    v_mfma_f32_16x16x32_bf16 v[56:59], v[68:71], v[148:151], v[56:59]
    v_mfma_f32_16x16x32_bf16 v[60:63], v[72:75], v[148:151], v[60:63]
    v_mfma_f32_16x16x32_bf16 v[56:59], v[64:67], v[152:155], v[56:59]
    v_mfma_f32_16x16x32_bf16 v[60:63], v[68:71], v[152:155], v[60:63]
    v_mfma_f32_16x16x32_bf16 v[60:63], v[64:67], v[156:159], v[60:63]
    s_waitcnt lgkmcnt(0)
    v_mfma_f32_16x16x32_bf16 v[32:35], v[96:99], v[160:163], v[32:35]
    ds_read_b128 v[128:131], v193 offset:128
    v_mfma_f32_16x16x32_bf16 v[36:39], v[100:103], v[160:163], v[36:39]
    ds_read_b64 v[64:65], v192 offset:3712
    v_mfma_f32_16x16x32_bf16 v[40:43], v[104:107], v[160:163], v[40:43]
    ds_read_b64 v[66:67], v192 offset:3720
    v_mfma_f32_16x16x32_bf16 v[44:47], v[108:111], v[160:163], v[44:47]
    ds_read_b128 v[132:135], v193 offset:640
    v_mfma_f32_16x16x32_bf16 v[48:51], v[112:115], v[160:163], v[48:51]
    ds_read_b64 v[68:69], v192 offset:3200
    v_mfma_f32_16x16x32_bf16 v[52:55], v[116:119], v[160:163], v[52:55]
    ds_read_b64 v[70:71], v192 offset:3208
    v_mfma_f32_16x16x32_bf16 v[56:59], v[120:123], v[160:163], v[56:59]
    ds_read_b128 v[136:139], v193 offset:1152
    v_mfma_f32_16x16x32_bf16 v[60:63], v[124:127], v[160:163], v[60:63]
    ds_read_b64 v[72:73], v192 offset:2688
    v_mfma_f32_16x16x32_bf16 v[36:39], v[96:99], v[164:167], v[36:39]
    ds_read_b64 v[74:75], v192 offset:2696
    v_mfma_f32_16x16x32_bf16 v[40:43], v[100:103], v[164:167], v[40:43]
    ds_read_b128 v[140:143], v193 offset:1664
    v_mfma_f32_16x16x32_bf16 v[44:47], v[104:107], v[164:167], v[44:47]
    ds_read_b64 v[76:77], v192 offset:2176
    v_mfma_f32_16x16x32_bf16 v[48:51], v[108:111], v[164:167], v[48:51]
    ds_read_b64 v[78:79], v192 offset:2184
    v_mfma_f32_16x16x32_bf16 v[52:55], v[112:115], v[164:167], v[52:55]
    ds_read_b128 v[144:147], v193 offset:2176
    v_mfma_f32_16x16x32_bf16 v[56:59], v[116:119], v[164:167], v[56:59]
    ds_read_b64 v[80:81], v192 offset:1664
    v_mfma_f32_16x16x32_bf16 v[60:63], v[120:123], v[164:167], v[60:63]
    ds_read_b64 v[82:83], v192 offset:1672
    v_mfma_f32_16x16x32_bf16 v[40:43], v[96:99], v[168:171], v[40:43]
    ds_read_b128 v[148:151], v193 offset:2688
    v_mfma_f32_16x16x32_bf16 v[44:47], v[100:103], v[168:171], v[44:47]
    ds_read_b64 v[84:85], v192 offset:1152
    v_mfma_f32_16x16x32_bf16 v[48:51], v[104:107], v[168:171], v[48:51]
    ds_read_b64 v[86:87], v192 offset:1160
    v_mfma_f32_16x16x32_bf16 v[52:55], v[108:111], v[168:171], v[52:55]
    ds_read_b128 v[152:155], v193 offset:3200
    v_mfma_f32_16x16x32_bf16 v[56:59], v[112:115], v[168:171], v[56:59]
    ds_read_b64 v[88:89], v192 offset:640
    v_mfma_f32_16x16x32_bf16 v[60:63], v[116:119], v[168:171], v[60:63]
    ds_read_b64 v[90:91], v192 offset:648
    v_mfma_f32_16x16x32_bf16 v[44:47], v[96:99], v[172:175], v[44:47]
    ds_read_b128 v[156:159], v193 offset:3712
    v_mfma_f32_16x16x32_bf16 v[48:51], v[100:103], v[172:175], v[48:51]
    ds_read_b64 v[92:93], v192 offset:128
    v_mfma_f32_16x16x32_bf16 v[52:55], v[104:107], v[172:175], v[52:55]
    ds_read_b64 v[94:95], v192 offset:136
    v_mfma_f32_16x16x32_bf16 v[56:59], v[108:111], v[172:175], v[56:59]
    v_mfma_f32_16x16x32_bf16 v[60:63], v[112:115], v[172:175], v[60:63]
    v_mfma_f32_16x16x32_bf16 v[48:51], v[96:99], v[176:179], v[48:51]
    v_mfma_f32_16x16x32_bf16 v[52:55], v[100:103], v[176:179], v[52:55]
    v_mfma_f32_16x16x32_bf16 v[56:59], v[104:107], v[176:179], v[56:59]
    v_mfma_f32_16x16x32_bf16 v[60:63], v[108:111], v[176:179], v[60:63]
    v_mfma_f32_16x16x32_bf16 v[52:55], v[96:99], v[180:183], v[52:55]
    v_mfma_f32_16x16x32_bf16 v[56:59], v[100:103], v[180:183], v[56:59]
    v_mfma_f32_16x16x32_bf16 v[60:63], v[104:107], v[180:183], v[60:63]
    v_mfma_f32_16x16x32_bf16 v[56:59], v[96:99], v[184:187], v[56:59]
    v_mfma_f32_16x16x32_bf16 v[60:63], v[100:103], v[184:187], v[60:63]
    v_mfma_f32_16x16x32_bf16 v[60:63], v[96:99], v[188:191], v[60:63]
    s_waitcnt lgkmcnt(0)
    v_mfma_f32_16x16x32_bf16 v[32:35], v[64:67], v[128:131], v[32:35]
    ds_read_b128 v[160:163], v193 offset:192
    v_mfma_f32_16x16x32_bf16 v[36:39], v[68:71], v[128:131], v[36:39]
    ds_read_b64 v[96:97], v192 offset:3776
    v_mfma_f32_16x16x32_bf16 v[40:43], v[72:75], v[128:131], v[40:43]
    ds_read_b64 v[98:99], v192 offset:3784
    v_mfma_f32_16x16x32_bf16 v[44:47], v[76:79], v[128:131], v[44:47]
    ds_read_b128 v[164:167], v193 offset:704
    v_mfma_f32_16x16x32_bf16 v[48:51], v[80:83], v[128:131], v[48:51]
    ds_read_b64 v[100:101], v192 offset:3264
    v_mfma_f32_16x16x32_bf16 v[52:55], v[84:87], v[128:131], v[52:55]
    ds_read_b64 v[102:103], v192 offset:3272
    v_mfma_f32_16x16x32_bf16 v[56:59], v[88:91], v[128:131], v[56:59]
    ds_read_b128 v[168:171], v193 offset:1216
    v_mfma_f32_16x16x32_bf16 v[60:63], v[92:95], v[128:131], v[60:63]
    ds_read_b64 v[104:105], v192 offset:2752
    v_mfma_f32_16x16x32_bf16 v[36:39], v[64:67], v[132:135], v[36:39]
    ds_read_b64 v[106:107], v192 offset:2760
    v_mfma_f32_16x16x32_bf16 v[40:43], v[68:71], v[132:135], v[40:43]
    ds_read_b128 v[172:175], v193 offset:1728
    v_mfma_f32_16x16x32_bf16 v[44:47], v[72:75], v[132:135], v[44:47]
    ds_read_b64 v[108:109], v192 offset:2240
    v_mfma_f32_16x16x32_bf16 v[48:51], v[76:79], v[132:135], v[48:51]
    ds_read_b64 v[110:111], v192 offset:2248
    v_mfma_f32_16x16x32_bf16 v[52:55], v[80:83], v[132:135], v[52:55]
    ds_read_b128 v[176:179], v193 offset:2240
    v_mfma_f32_16x16x32_bf16 v[56:59], v[84:87], v[132:135], v[56:59]
    ds_read_b64 v[112:113], v192 offset:1728
    v_mfma_f32_16x16x32_bf16 v[60:63], v[88:91], v[132:135], v[60:63]
    ds_read_b64 v[114:115], v192 offset:1736
    v_mfma_f32_16x16x32_bf16 v[40:43], v[64:67], v[136:139], v[40:43]
    ds_read_b128 v[180:183], v193 offset:2752
    v_mfma_f32_16x16x32_bf16 v[44:47], v[68:71], v[136:139], v[44:47]
    ds_read_b64 v[116:117], v192 offset:1216
    v_mfma_f32_16x16x32_bf16 v[48:51], v[72:75], v[136:139], v[48:51]
    ds_read_b64 v[118:119], v192 offset:1224
    v_mfma_f32_16x16x32_bf16 v[52:55], v[76:79], v[136:139], v[52:55]
    ds_read_b128 v[184:187], v193 offset:3264
    v_mfma_f32_16x16x32_bf16 v[56:59], v[80:83], v[136:139], v[56:59]
    ds_read_b64 v[120:121], v192 offset:704
    v_mfma_f32_16x16x32_bf16 v[60:63], v[84:87], v[136:139], v[60:63]
    ds_read_b64 v[122:123], v192 offset:712
    v_mfma_f32_16x16x32_bf16 v[44:47], v[64:67], v[140:143], v[44:47]
    ds_read_b128 v[188:191], v193 offset:3776
    v_mfma_f32_16x16x32_bf16 v[48:51], v[68:71], v[140:143], v[48:51]
    ds_read_b64 v[124:125], v192 offset:192
    v_mfma_f32_16x16x32_bf16 v[52:55], v[72:75], v[140:143], v[52:55]
    ds_read_b64 v[126:127], v192 offset:200
    v_mfma_f32_16x16x32_bf16 v[56:59], v[76:79], v[140:143], v[56:59]
    v_mfma_f32_16x16x32_bf16 v[60:63], v[80:83], v[140:143], v[60:63]
    v_mfma_f32_16x16x32_bf16 v[48:51], v[64:67], v[144:147], v[48:51]
    v_mfma_f32_16x16x32_bf16 v[52:55], v[68:71], v[144:147], v[52:55]
    v_mfma_f32_16x16x32_bf16 v[56:59], v[72:75], v[144:147], v[56:59]
    v_mfma_f32_16x16x32_bf16 v[60:63], v[76:79], v[144:147], v[60:63]
    v_mfma_f32_16x16x32_bf16 v[52:55], v[64:67], v[148:151], v[52:55]
    v_mfma_f32_16x16x32_bf16 v[56:59], v[68:71], v[148:151], v[56:59]
    v_mfma_f32_16x16x32_bf16 v[60:63], v[72:75], v[148:151], v[60:63]
    v_mfma_f32_16x16x32_bf16 v[56:59], v[64:67], v[152:155], v[56:59]
    v_mfma_f32_16x16x32_bf16 v[60:63], v[68:71], v[152:155], v[60:63]
    v_mfma_f32_16x16x32_bf16 v[60:63], v[64:67], v[156:159], v[60:63]
    s_waitcnt lgkmcnt(0)
    v_mfma_f32_16x16x32_bf16 v[32:35], v[96:99], v[160:163], v[32:35]
    v_mfma_f32_16x16x32_bf16 v[36:39], v[100:103], v[160:163], v[36:39]
    v_mfma_f32_16x16x32_bf16 v[40:43], v[104:107], v[160:163], v[40:43]
    v_mfma_f32_16x16x32_bf16 v[44:47], v[108:111], v[160:163], v[44:47]
    v_mfma_f32_16x16x32_bf16 v[48:51], v[112:115], v[160:163], v[48:51]
    v_mfma_f32_16x16x32_bf16 v[52:55], v[116:119], v[160:163], v[52:55]
    v_mfma_f32_16x16x32_bf16 v[56:59], v[120:123], v[160:163], v[56:59]
    v_mfma_f32_16x16x32_bf16 v[60:63], v[124:127], v[160:163], v[60:63]
    v_mfma_f32_16x16x32_bf16 v[36:39], v[96:99], v[164:167], v[36:39]
    v_mfma_f32_16x16x32_bf16 v[40:43], v[100:103], v[164:167], v[40:43]
    v_mfma_f32_16x16x32_bf16 v[44:47], v[104:107], v[164:167], v[44:47]
    v_mfma_f32_16x16x32_bf16 v[48:51], v[108:111], v[164:167], v[48:51]
    v_mfma_f32_16x16x32_bf16 v[52:55], v[112:115], v[164:167], v[52:55]
    v_mfma_f32_16x16x32_bf16 v[56:59], v[116:119], v[164:167], v[56:59]
    v_mfma_f32_16x16x32_bf16 v[60:63], v[120:123], v[164:167], v[60:63]
    v_mfma_f32_16x16x32_bf16 v[40:43], v[96:99], v[168:171], v[40:43]
    v_mfma_f32_16x16x32_bf16 v[44:47], v[100:103], v[168:171], v[44:47]
    v_mfma_f32_16x16x32_bf16 v[48:51], v[104:107], v[168:171], v[48:51]
    v_mfma_f32_16x16x32_bf16 v[52:55], v[108:111], v[168:171], v[52:55]
    v_mfma_f32_16x16x32_bf16 v[56:59], v[112:115], v[168:171], v[56:59]
    v_mfma_f32_16x16x32_bf16 v[60:63], v[116:119], v[168:171], v[60:63]
    v_mfma_f32_16x16x32_bf16 v[44:47], v[96:99], v[172:175], v[44:47]
    v_mfma_f32_16x16x32_bf16 v[48:51], v[100:103], v[172:175], v[48:51]
    v_mfma_f32_16x16x32_bf16 v[52:55], v[104:107], v[172:175], v[52:55]
    v_mfma_f32_16x16x32_bf16 v[56:59], v[108:111], v[172:175], v[56:59]
    v_mfma_f32_16x16x32_bf16 v[60:63], v[112:115], v[172:175], v[60:63]
    v_mfma_f32_16x16x32_bf16 v[48:51], v[96:99], v[176:179], v[48:51]
    v_mfma_f32_16x16x32_bf16 v[52:55], v[100:103], v[176:179], v[52:55]
    v_mfma_f32_16x16x32_bf16 v[56:59], v[104:107], v[176:179], v[56:59]
    v_mfma_f32_16x16x32_bf16 v[60:63], v[108:111], v[176:179], v[60:63]
    v_mfma_f32_16x16x32_bf16 v[52:55], v[96:99], v[180:183], v[52:55]
    v_mfma_f32_16x16x32_bf16 v[56:59], v[100:103], v[180:183], v[56:59]
    v_mfma_f32_16x16x32_bf16 v[60:63], v[104:107], v[180:183], v[60:63]
    v_mfma_f32_16x16x32_bf16 v[56:59], v[96:99], v[184:187], v[56:59]
    v_mfma_f32_16x16x32_bf16 v[60:63], v[100:103], v[184:187], v[60:63]
    v_mfma_f32_16x16x32_bf16 v[60:63], v[96:99], v[188:191], v[60:63]
    s_lshl_b32 s39, s35, 12
    s_add_u32 s39, s39, 40960
    v_lshl_add_u32 v2, v1, 4, s39
    s_xor_b32 s42, s35, 1
    s_lshl_b32 s42, s42, 12
    s_add_u32 s42, s42, 40960
    v_lshl_add_u32 v3, v1, 4, s42
    v_and_b32 v4, 15, v1
    v_lshrrev_b32 v5, 4, v1
    v_lshlrev_b32 v6, 5, v4
    v_lshl_add_u32 v6, v5, 3, v6
    s_mul_i32 s42, s37, 4608
    s_lshl_b32 s39, s36, 11
    s_add_u32 s42, s42, s39
    s_add_u32 s42, s42, 70112
    v_add_u32 v6, s42, v6
    ds_read_b64 v[96:97], v6
    ds_read_b64 v[98:99], v6 offset:512
    ds_read_b64 v[100:101], v6 offset:1024
    ds_read_b64 v[102:103], v6 offset:1536
    s_cmp_eq_u32 s36, 0
    s_cbranch_scc0 L_B_ce1
    ds_write_b128 v2, v[48:51] offset:0
    ds_write_b128 v2, v[52:55] offset:1024
    ds_write_b128 v2, v[56:59] offset:2048
    ds_write_b128 v2, v[60:63] offset:3072
    s_branch L_B_ce2
L_B_ce1:
    ds_write_b128 v2, v[32:35] offset:0
    ds_write_b128 v2, v[36:39] offset:1024
    ds_write_b128 v2, v[40:43] offset:2048
    ds_write_b128 v2, v[44:47] offset:3072
    v_mov_b32 v32, v48
    v_mov_b32 v33, v49
    v_mov_b32 v34, v50
    v_mov_b32 v35, v51
    v_mov_b32 v36, v52
    v_mov_b32 v37, v53
    v_mov_b32 v38, v54
    v_mov_b32 v39, v55
    v_mov_b32 v40, v56
    v_mov_b32 v41, v57
    v_mov_b32 v42, v58
    v_mov_b32 v43, v59
    v_mov_b32 v44, v60
    v_mov_b32 v45, v61
    v_mov_b32 v46, v62
    v_mov_b32 v47, v63
L_B_ce2:
    s_waitcnt lgkmcnt(0)
    s_barrier
    ds_read_b128 v[64:67], v3 offset:0
    ds_read_b128 v[68:71], v3 offset:1024
    ds_read_b128 v[72:75], v3 offset:2048
    ds_read_b128 v[76:79], v3 offset:3072
    v_mov_b32 v7, s41
    s_mov_b32 s46, 0xffff0000
    s_lshl_b32 s39, s38, 12
    s_lshl_b32 s42, s36, 11
    s_add_u32 s39, s39, s42
    s_add_u32 s39, s39, 4194304
    v_and_b32 v8, 1, v5
    v_lshlrev_b32 v8, 9, v8
    v_lshrrev_b32 v9, 1, v5
    v_lshl_add_u32 v8, v9, 6, v8
    v_lshrrev_b32 v9, 2, v4
    v_lshl_add_u32 v8, v9, 7, v8
    v_and_b32 v9, 3, v4
    v_lshl_add_u32 v8, v9, 4, v8
    v_add_u32 v8, s39, v8
    s_waitcnt lgkmcnt(0)
    v_lshlrev_b32 v10, 16, v96
    v_and_b32 v11, s46, v96
    v_lshlrev_b32 v12, 16, v97
    v_and_b32 v13, s46, v97
    v_add_f32 v64, v64, v32
    v_add_f32 v65, v65, v33
    v_add_f32 v66, v66, v34
    v_add_f32 v67, v67, v35
    v_fmac_f32 v64, v7, v10
    v_fmac_f32 v65, v7, v11
    v_fmac_f32 v66, v7, v12
    v_fmac_f32 v67, v7, v13
    v_cvt_pk_bf16_f32 v112, v64, v65
    v_cvt_pk_bf16_f32 v113, v66, v67
    v_lshlrev_b32 v10, 16, v98
    v_and_b32 v11, s46, v98
    v_lshlrev_b32 v12, 16, v99
    v_and_b32 v13, s46, v99
    v_add_f32 v68, v68, v36
    v_add_f32 v69, v69, v37
    v_add_f32 v70, v70, v38
    v_add_f32 v71, v71, v39
    v_fmac_f32 v68, v7, v10
    v_fmac_f32 v69, v7, v11
    v_fmac_f32 v70, v7, v12
    v_fmac_f32 v71, v7, v13
    v_cvt_pk_bf16_f32 v114, v68, v69
    v_cvt_pk_bf16_f32 v115, v70, v71
    v_lshlrev_b32 v10, 16, v100
    v_and_b32 v11, s46, v100
    v_lshlrev_b32 v12, 16, v101
    v_and_b32 v13, s46, v101
    v_add_f32 v72, v72, v40
    v_add_f32 v73, v73, v41
    v_add_f32 v74, v74, v42
    v_add_f32 v75, v75, v43
    v_fmac_f32 v72, v7, v10
    v_fmac_f32 v73, v7, v11
    v_fmac_f32 v74, v7, v12
    v_fmac_f32 v75, v7, v13
    v_cvt_pk_bf16_f32 v116, v72, v73
    v_cvt_pk_bf16_f32 v117, v74, v75
    v_lshlrev_b32 v10, 16, v102
    v_and_b32 v11, s46, v102
    v_lshlrev_b32 v12, 16, v103
    v_and_b32 v13, s46, v103
    v_add_f32 v76, v76, v44
    v_add_f32 v77, v77, v45
    v_add_f32 v78, v78, v46
    v_add_f32 v79, v79, v47
    v_fmac_f32 v76, v7, v10
    v_fmac_f32 v77, v7, v11
    v_fmac_f32 v78, v7, v12
    v_fmac_f32 v79, v7, v13
    v_cvt_pk_bf16_f32 v118, v76, v77
    v_cvt_pk_bf16_f32 v119, v78, v79
    v_permlane16_swap_b32 v112, v114
    v_permlane16_swap_b32 v113, v115
    v_permlane16_swap_b32 v116, v118
    v_permlane16_swap_b32 v117, v119
    s_setprio 3
    global_store_dwordx4 v8, v[112:115], s[30:31] sc1
    global_store_dwordx4 v8, v[116:119], s[30:31] offset:1024 sc1
    s_setprio 0
    v_lshrrev_b32 v2, 2, v0
    v_and_b32 v3, 3, v0
    s_lshl_b32 s39, s33, 18
    s_lshr_b32 s42, s34, 2
    s_lshl_b32 s42, s42, 9
    s_add_u32 s39, s39, s42
    s_and_b32 s42, s34, 3
    s_lshl_b32 s42, s42, 7
    s_add_u32 s39, s39, s42
    s_add_u32 s39, s39, 4194304
    v_lshlrev_b32 v6, 12, v2
    v_lshl_add_u32 v6, v3, 4, v6
    v_add_u32 v6, s39, v6
    v_mul_u32_u24 v7, 144, v2
    v_lshl_add_u32 v7, v3, 5, v7
    v_add_u32 v7, 0, v7
    s_lshl_b32 s39, s33, 7
    s_add_u32 s39, s39, 5120
    v_and_b32 v20, 31, v1
    v_lshl_add_u32 v20, v20, 2, s39
    s_waitcnt vmcnt(0)
    s_mov_b32 s60, 0
L_B_t1poll:
    s_setprio 3
    global_load_dwordx4 v[12:15], v6, s[30:31] sc1
    global_load_dwordx4 v[16:19], v6, s[30:31] offset:64 sc1
    s_setprio 0
    s_waitcnt vmcnt(0)
    v_max3_u32 v10, v12, v13, v14
    v_max3_u32 v11, v15, v16, v17
    v_max3_u32 v10, v10, v18, v19
    v_max_u32 v10, v10, v11
    v_cmp_eq_u32 vcc, -1, v10
    s_nop 0
    s_cmp_eq_u64 vcc, 0
    s_cbranch_scc1 L_B_t1ok
    s_add_u32 s60, s60, 1
    s_cmp_gt_u32 s60, 30000
    s_cbranch_scc0 L_B_t1poll
L_B_t1ok:
    v_lshrrev_b32 v9, 4, v1
    v_and_b32 v10, 15, v1
    v_lshrrev_b32 v11, 2, v10
    v_lshl_add_u32 v11, v9, 3, v11
    v_mul_u32_u24 v11, 144, v11
    v_and_b32 v24, 3, v10
    v_lshl_add_u32 v11, v24, 3, v11
    s_lshl_b32 s39, s35, 5
    s_add_u32 s39, s39, 0
    v_add_u32 v11, s39, v11
    s_mul_i32 s39, s35, 2304
    s_add_u32 s39, s39, 16384
    v_mul_u32_u24 v24, 144, v10
    v_lshl_add_u32 v24, v9, 4, v24
    v_add_u32 v24, s39, v24
    v_lshrrev_b32 v25, 3, v1
    v_and_b32 v26, 7, v1
    v_mul_u32_u24 v27, 144, v25
    v_lshl_add_u32 v27, v26, 4, v27
    v_add_u32 v27, s39, v27
    s_lshl_b32 s39, s34, 6
    s_lshl_b32 s42, s35, 4
    s_add_u32 s39, s39, s42
    s_mul_i32 s39, s39, 1792
    s_lshl_b32 s42, s33, 7
    s_add_u32 s39, s39, s42
    s_add_u32 s39, s39, 896
    v_mul_u32_u24 v28, 1792, v25
    v_lshl_add_u32 v28, v26, 4, v28
    v_add_u32 v28, s39, v28
    v_add_u32 v29, 14336, v28
    ds_write_b128 v7, v[12:15]
    ds_write_b128 v7, v[16:19] offset:16
    s_waitcnt lgkmcnt(0)
    s_barrier
    ds_read_b64_tr_b16 v[12:13], v11
    ds_read_b64_tr_b16 v[14:15], v11 offset:576
    ds_read_b64_tr_b16 v[16:17], v11 offset:4608
    ds_read_b64_tr_b16 v[18:19], v11 offset:5184
    s_waitcnt lgkmcnt(0)
    ds_write_b128 v24, v[12:15]
    ds_write_b128 v24, v[16:19] offset:64
    s_waitcnt lgkmcnt(0)
    ds_read_b128 v[12:15], v27
    ds_read_b128 v[16:19], v27 offset:1152
    s_waitcnt lgkmcnt(0)
    s_setprio 3
    global_store_dwordx4 v28, v[12:15], s[26:27]
    global_store_dwordx4 v29, v[16:19], s[26:27]
    s_setprio 0
    s_endpgm
L_A:
    s_setprio 2
    s_sub_u32 s37, s2, 225
    v_lshrrev_b32 v2, 6, v0
    v_and_b32 v1, 63, v0
    v_readfirstlane_b32 s34, v2
    s_and_b32 s39, s37, 3
    s_lshl_b32 s39, s39, 2
    s_bfe_u32 s40, s37, 0x20003
    s_add_u32 s32, s39, s40
    s_bfe_u32 s39, s37, 0x10002
    s_lshl_b32 s39, s39, 3
    s_lshr_b32 s40, s37, 5
    s_add_u32 s33, s39, s40
    s_bfe_u32 s36, s37, 0x20003
    s_and_b32 s39, s37, 7
    s_lshl_b32 s39, s39, 3
    s_lshr_b32 s40, s37, 5
    s_add_u32 s35, s39, s40
    v_bfe_u32 v2, v1, 2, 3
    s_lshl_b32 s39, s32, 7
    v_mul_u32_u24 v2, 3584, v2
    v_lshrrev_b32 v3, 5, v1
    s_lshl_b32 s40, s34, 5
    v_lshl_add_u32 v2, v3, 6, v2
    s_add_u32 s39, s39, s40
    v_and_b32 v3, 3, v1
    s_mul_i32 s39, s39, 896
    v_lshl_add_u32 v2, v3, 4, v2
    v_add_u32 v4, s39, v2
    s_and_b32 s39, s33, 7
    s_and_b32 s40, s32, 3
    s_lshl_b32 s40, s40, 1
    s_add_u32 s39, s39, s40
    s_mul_i32 s39, s39, 1
    s_cmp_ge_u32 s39, 7
    s_cselect_b32 s40, 7, 0
    s_sub_u32 s61, s39, s40
    s_waitcnt lgkmcnt(0)
    s_mov_b32 s20, s4
    s_mov_b32 s21, s5
    s_mov_b32 s22, 1835008
    s_mov_b32 s23, 0x00020000
    s_lshl_b32 s12, s61, 7
    buffer_load_dwordx4 v[16:19], v4, s[20:23], s12 offen offset:0
    buffer_load_dwordx4 v[20:23], v4, s[20:23], s12 offen offset:896
    buffer_load_dwordx4 v[24:27], v4, s[20:23], s12 offen offset:1792
    buffer_load_dwordx4 v[28:31], v4, s[20:23], s12 offen offset:2688
    s_add_u32 s13, s12, 128
    s_cmp_eq_u32 s13, 896
    s_cselect_b32 s13, 0, s13
    s_add_u32 s14, s13, 128
    s_cmp_eq_u32 s14, 896
    s_cselect_b32 s14, 0, s14
    s_add_u32 s15, s14, 128
    s_cmp_eq_u32 s15, 896
    s_cselect_b32 s15, 0, s15
    s_add_u32 s16, s15, 128
    s_cmp_eq_u32 s16, 896
    s_cselect_b32 s16, 0, s16
    s_add_u32 s17, s16, 128
    s_cmp_eq_u32 s17, 896
    s_cselect_b32 s17, 0, s17
    s_add_u32 s18, s17, 128
    v_lshrrev_b32 v2, 5, v1
    v_bfe_u32 v3, v1, 2, 2
    s_cmp_eq_u32 s18, 896
    v_lshl_add_u32 v2, v2, 2, v3
    s_cselect_b32 s18, 0, s18
    v_bfe_u32 v3, v1, 4, 1
    s_lshl_b32 s62, s34, 10
    s_mul_i32 s41, s33, 56
    v_mul_u32_u24 v2, 2688, v2
    v_mul_u32_u24 v3, 896, v3
    s_and_b32 s61, s41, 8
    v_add_u32 v2, v2, v3
    s_and_b32 s41, s41, 0xfffffff0
    v_and_b32 v3, 3, v1
    v_lshl_add_u32 v2, v3, 4, v2
    s_add_u32 s39, s41, 896
    v_add_u32 v8, s39, v2
    s_mov_b32 s64, s6
    s_mov_b32 s65, s7
    s_mov_b32 s66, 1204224
    s_mov_b32 s67, 0x00020000
    s_mul_i32 s63, s34, 21504
    s_add_u32 m0, s62, 0
    s_mul_i32 s42, s12, 1344
    s_add_u32 s42, s42, s63
    buffer_load_dwordx4 v8, s[64:67], s42 offen lds
    s_add_u32 m0, s62, 4096
    s_mul_i32 s42, s12, 1344
    s_add_u32 s42, s42, s63
    s_add_u32 s42, s42, 86016
    buffer_load_dwordx4 v8, s[64:67], s42 offen lds
    s_add_u32 m0, s62, 8192
    s_mul_i32 s42, s13, 1344
    s_add_u32 s42, s42, s63
    buffer_load_dwordx4 v8, s[64:67], s42 offen lds
    s_add_u32 m0, s62, 12288
    s_mul_i32 s42, s13, 1344
    s_add_u32 s42, s42, s63
    s_add_u32 s42, s42, 86016
    buffer_load_dwordx4 v8, s[64:67], s42 offen lds
    buffer_load_dwordx4 v[32:35], v4, s[20:23], s13 offen offset:0
    v_lshrrev_b32 v2, 2, v1
    v_mul_u32_u24 v2, 2688, v2
    v_lshl_add_u32 v2, v3, 4, v2
    buffer_load_dwordx4 v[36:39], v4, s[20:23], s13 offen offset:896
    v_add_u32 v9, s41, v2
    v_and_b32 v2, 15, v1
    v_lshrrev_b32 v3, 2, v2
    buffer_load_dwordx4 v[40:43], v4, s[20:23], s13 offen offset:1792
    v_and_b32 v2, 3, v2
    s_and_b32 s39, s36, 1
    v_lshlrev_b32 v2, 3, v2
    buffer_load_dwordx4 v[44:47], v4, s[20:23], s13 offen offset:2688
    v_bfe_u32 v10, v1, 4, 1
    s_lshl_b32 s39, s39, 5
    s_mul_i32 s40, s34, 56
    v_lshl_add_u32 v2, v10, 5, v2
    s_add_u32 s39, s39, s40
    v_add_u32 v13, s39, v2
    v_lshrrev_b32 v11, 5, v1
    v_lshrrev_b32 v14, 4, v13
    v_lshl_add_u32 v12, v11, 2, v3
    v_lshl_add_u32 v14, v3, 2, v14
    v_mul_u32_u24 v12, 56, v12
    v_and_b32 v14, 15, v14
    v_and_b32 v13, 15, v13
    v_lshl_add_u32 v10, v3, 6, v2
    v_add_u32 v12, v12, v2
    v_lshl_add_u32 v13, v14, 4, v13
    v_lshl_add_u32 v13, v3, 8, v13
    v_and_b32 v2, 31, v1
    v_lshrrev_b32 v3, 4, v2
    v_lshlrev_b32 v3, 2, v3
    v_bfe_u32 v14, v2, 3, 1
    v_lshl_add_u32 v3, v14, 1, v3
    v_bfe_u32 v14, v2, 1, 1
    v_add_u32 v3, v3, v14
    v_bfe_u32 v14, v2, 2, 1
    v_xor_b32 v14, v14, v11
    v_lshl_add_u32 v3, v14, 4, v3
    v_and_b32 v14, 1, v2
    v_lshlrev_b32 v14, 4, v14
    v_mov_b32 v15, 0x3f80
    v_cmp_eq_u32 s[40:41], 0, v3
    v_lshlrev_b32 v15, v14, v15
    v_add_u32 v10, s61, v10
    v_cndmask_b32_e64 v196, 0, v15, s[40:41]
    v_cmp_eq_u32 s[40:41], 1, v3
    v_lshl_add_u32 v7, v11, 11, v10
    s_mul_i32 s19, s34, 43008
    v_cndmask_b32_e64 v197, 0, v15, s[40:41]
    v_cmp_eq_u32 s[40:41], 2, v3
    s_mov_b32 s44, 0x55555555
    s_mov_b32 s45, 0x55555555
    v_cndmask_b32_e64 v198, 0, v15, s[40:41]
    v_cmp_eq_u32 s[40:41], 3, v3
    s_mov_b32 s46, 0xaaaaaaaa
    s_mov_b32 s47, 0xaaaaaaaa
    v_cndmask_b32_e64 v199, 0, v15, s[40:41]
    v_cmp_eq_u32 s[40:41], 4, v3
    s_mov_b32 s48, 0x33333333
    s_mov_b32 s49, 0x33333333
    v_cndmask_b32_e64 v200, 0, v15, s[40:41]
    v_cmp_eq_u32 s[40:41], 5, v3
    s_mov_b32 s50, 0xcccccccc
    s_mov_b32 s51, 0xcccccccc
    v_cndmask_b32_e64 v201, 0, v15, s[40:41]
    v_cmp_eq_u32 s[40:41], 6, v3
    s_mov_b32 s52, 0
    s_mov_b32 s53, -1
    v_cndmask_b32_e64 v202, 0, v15, s[40:41]
    v_cmp_eq_u32 s[40:41], 7, v3
    s_mov_b32 s54, 0xf0000000
    s_mov_b32 s55, 0xf0000000
    s_mov_b32 s56, 0x3fb8aa3b
    s_mov_b32 s57, 0x3fb8aa3b
    s_mov_b32 s58, 0x00003f80
    s_mov_b32 s59, 0x3f800000
    s_mov_b32 s68, s8
    s_mov_b32 s69, s9
    s_mov_b32 s70, 25088
    s_mov_b32 s71, 0x00020000
    s_mov_b32 s72, s10
    s_mov_b32 s73, s11
    s_mov_b32 s74, 401408
    s_mov_b32 s75, 0x00020000
    v_lshl_add_u32 v5, v11, 12, v10
    v_add_u32 v6, 53248, v7
    v_add_u32 v12, 4096, v12
    v_lshl_add_u32 v13, v11, 10, v13
    v_mov_b32 v140, 0
    v_mov_b32 v156, 0
    v_mov_b32 v141, 0
    v_mov_b32 v157, 0
    v_mov_b32 v142, 0
    v_mov_b32 v158, 0
    v_mov_b32 v143, 0
    v_mov_b32 v159, 0
    v_mov_b32 v144, 0
    v_mov_b32 v160, 0
    v_mov_b32 v145, 0
    v_mov_b32 v161, 0
    v_mov_b32 v146, 0
    v_mov_b32 v162, 0
    v_mov_b32 v147, 0
    v_mov_b32 v163, 0
    v_mov_b32 v148, 0
    v_mov_b32 v164, 0
    v_mov_b32 v149, 0
    v_mov_b32 v165, 0
    v_mov_b32 v150, 0
    v_mov_b32 v166, 0
    v_mov_b32 v151, 0
    v_mov_b32 v167, 0
    v_mov_b32 v152, 0
    v_mov_b32 v168, 0
    v_mov_b32 v153, 0
    v_mov_b32 v169, 0
    v_mov_b32 v154, 0
    v_mov_b32 v170, 0
    v_mov_b32 v155, 0
    v_mov_b32 v171, 0
    v_cndmask_b32_e64 v203, 0, v15, s[40:41]
    s_waitcnt vmcnt(8)
    buffer_load_dwordx4 v[48:51], v4, s[20:23], s14 offen offset:0
    s_mov_b64 vcc, s[44:45]
    v_cndmask_b32_dpp v132, v28, v24, vcc quad_perm:[1,0,3,2] row_mask:0xf bank_mask:0xf
    v_mov_b32_dpp v137, v24 quad_perm:[1,0,3,2] row_mask:0xf bank_mask:0xf
    v_cndmask_b32_dpp v133, v29, v25, vcc quad_perm:[1,0,3,2] row_mask:0xf bank_mask:0xf
    v_mov_b32_dpp v139, v25 quad_perm:[1,0,3,2] row_mask:0xf bank_mask:0xf
    v_cndmask_b32_dpp v128, v20, v16, vcc quad_perm:[1,0,3,2] row_mask:0xf bank_mask:0xf
    v_mov_b32_dpp v136, v16 quad_perm:[1,0,3,2] row_mask:0xf bank_mask:0xf
    v_cndmask_b32_e64 v28, v137, v28, s[46:47]
    v_cndmask_b32_dpp v129, v21, v17, vcc quad_perm:[1,0,3,2] row_mask:0xf bank_mask:0xf
    v_mov_b32_dpp v138, v17 quad_perm:[1,0,3,2] row_mask:0xf bank_mask:0xf
    v_cndmask_b32_e64 v29, v139, v29, s[46:47]
    buffer_load_dwordx4 v[52:55], v4, s[20:23], s14 offen offset:896
    v_cndmask_b32_e64 v20, v136, v20, s[46:47]
    v_cndmask_b32_e64 v21, v138, v21, s[46:47]
    v_cndmask_b32_dpp v134, v30, v26, vcc quad_perm:[1,0,3,2] row_mask:0xf bank_mask:0xf
    v_mov_b32_dpp v137, v26 quad_perm:[1,0,3,2] row_mask:0xf bank_mask:0xf
    v_cndmask_b32_dpp v135, v31, v27, vcc quad_perm:[1,0,3,2] row_mask:0xf bank_mask:0xf
    v_mov_b32_dpp v139, v27 quad_perm:[1,0,3,2] row_mask:0xf bank_mask:0xf
    v_cndmask_b32_dpp v130, v22, v18, vcc quad_perm:[1,0,3,2] row_mask:0xf bank_mask:0xf
    v_cndmask_b32_e64 v30, v137, v30, s[46:47]
    v_cndmask_b32_dpp v131, v23, v19, vcc quad_perm:[1,0,3,2] row_mask:0xf bank_mask:0xf
    v_cndmask_b32_e64 v31, v139, v31, s[46:47]
    v_mov_b32_dpp v136, v18 quad_perm:[1,0,3,2] row_mask:0xf bank_mask:0xf
    buffer_load_dwordx4 v[56:59], v4, s[20:23], s14 offen offset:1792
    v_mov_b32_dpp v138, v19 quad_perm:[1,0,3,2] row_mask:0xf bank_mask:0xf
    s_mov_b64 vcc, s[48:49]
    v_mov_b32_dpp v137, v20 quad_perm:[2,3,0,1] row_mask:0xf bank_mask:0xf
    v_mov_b32_dpp v139, v21 quad_perm:[2,3,0,1] row_mask:0xf bank_mask:0xf
    v_cndmask_b32_e64 v22, v136, v22, s[46:47]
    v_cndmask_b32_e64 v23, v138, v23, s[46:47]
    v_cndmask_b32_dpp v20, v28, v20, vcc quad_perm:[2,3,0,1] row_mask:0xf bank_mask:0xf
    v_mov_b32_dpp v136, v128 quad_perm:[2,3,0,1] row_mask:0xf bank_mask:0xf
    v_cndmask_b32_dpp v21, v29, v21, vcc quad_perm:[2,3,0,1] row_mask:0xf bank_mask:0xf
    v_cndmask_b32_e64 v28, v137, v28, s[50:51]
    v_mov_b32_dpp v138, v129 quad_perm:[2,3,0,1] row_mask:0xf bank_mask:0xf
    buffer_load_dwordx4 v[60:63], v4, s[20:23], s14 offen offset:2688
    v_cndmask_b32_e64 v29, v139, v29, s[50:51]
    v_cndmask_b32_e64 v24, v136, v132, s[50:51]
    v_cndmask_b32_e64 v25, v138, v133, s[50:51]
    v_mov_b32_dpp v137, v22 quad_perm:[2,3,0,1] row_mask:0xf bank_mask:0xf
    v_mov_b32_dpp v139, v23 quad_perm:[2,3,0,1] row_mask:0xf bank_mask:0xf
    v_mov_b32_dpp v136, v130 quad_perm:[2,3,0,1] row_mask:0xf bank_mask:0xf
    v_cndmask_b32_dpp v22, v30, v22, vcc quad_perm:[2,3,0,1] row_mask:0xf bank_mask:0xf
    v_mov_b32_dpp v138, v131 quad_perm:[2,3,0,1] row_mask:0xf bank_mask:0xf
    v_cndmask_b32_dpp v23, v31, v23, vcc quad_perm:[2,3,0,1] row_mask:0xf bank_mask:0xf
    v_cndmask_b32_e64 v26, v136, v134, s[50:51]
    v_cndmask_b32_dpp v16, v132, v128, vcc quad_perm:[2,3,0,1] row_mask:0xf bank_mask:0xf
    s_add_u32 m0, s62, 16384
    s_mul_i32 s42, s14, 1344
    s_add_u32 s42, s42, s63
    buffer_load_dwordx4 v8, s[64:67], s42 offen lds
    v_cndmask_b32_e64 v30, v137, v30, s[50:51]
    v_cndmask_b32_dpp v17, v133, v129, vcc quad_perm:[2,3,0,1] row_mask:0xf bank_mask:0xf
    v_cndmask_b32_e64 v27, v138, v135, s[50:51]
    v_cndmask_b32_dpp v18, v134, v130, vcc quad_perm:[2,3,0,1] row_mask:0xf bank_mask:0xf
    v_cndmask_b32_e64 v31, v139, v31, s[50:51]
    v_cndmask_b32_dpp v19, v135, v131, vcc quad_perm:[2,3,0,1] row_mask:0xf bank_mask:0xf
    s_add_u32 m0, s62, 20480
    s_mul_i32 s42, s14, 1344
    s_add_u32 s42, s42, s63
    s_add_u32 s42, s42, 86016
    buffer_load_dwordx4 v8, s[64:67], s42 offen lds
    s_add_u32 m0, s62, 24576
    s_mul_i32 s42, s15, 1344
    s_add_u32 s42, s42, s63
    buffer_load_dwordx4 v8, s[64:67], s42 offen lds
    s_add_u32 m0, s62, 28672
    s_mul_i32 s42, s15, 1344
    s_add_u32 s42, s42, s63
    s_add_u32 s42, s42, 86016
    buffer_load_dwordx4 v8, s[64:67], s42 offen lds
    s_waitcnt vmcnt(12)
    s_barrier
    ds_read_b64_tr_b16 v[172:173], v5 offset:0
    ds_read_b64_tr_b16 v[174:175], v5 offset:512
    ds_read_b64_tr_b16 v[176:177], v5 offset:256
    ds_read_b64_tr_b16 v[178:179], v5 offset:768
    ds_read_b64_tr_b16 v[180:181], v5 offset:1024
    ds_read_b64_tr_b16 v[182:183], v5 offset:1536
    ds_read_b64_tr_b16 v[184:185], v5 offset:1280
    ds_read_b64_tr_b16 v[186:187], v5 offset:1792
    s_waitcnt vmcnt(8)
    s_mov_b64 vcc, s[44:45]
    v_cndmask_b32_dpp v128, v36, v32, vcc quad_perm:[1,0,3,2] row_mask:0xf bank_mask:0xf
    v_mov_b32_dpp v136, v32 quad_perm:[1,0,3,2] row_mask:0xf bank_mask:0xf
    v_cndmask_b32_dpp v129, v37, v33, vcc quad_perm:[1,0,3,2] row_mask:0xf bank_mask:0xf
    v_mov_b32_dpp v138, v33 quad_perm:[1,0,3,2] row_mask:0xf bank_mask:0xf
    v_cndmask_b32_dpp v132, v44, v40, vcc quad_perm:[1,0,3,2] row_mask:0xf bank_mask:0xf
    v_cndmask_b32_e64 v36, v136, v36, s[46:47]
    v_cndmask_b32_dpp v133, v45, v41, vcc quad_perm:[1,0,3,2] row_mask:0xf bank_mask:0xf
    v_cndmask_b32_e64 v37, v138, v37, s[46:47]
    v_cndmask_b32_dpp v130, v38, v34, vcc quad_perm:[1,0,3,2] row_mask:0xf bank_mask:0xf
    v_mov_b32_dpp v136, v34 quad_perm:[1,0,3,2] row_mask:0xf bank_mask:0xf
    v_cndmask_b32_dpp v134, v46, v42, vcc quad_perm:[1,0,3,2] row_mask:0xf bank_mask:0xf
    v_mov_b32_dpp v138, v35 quad_perm:[1,0,3,2] row_mask:0xf bank_mask:0xf
    v_cndmask_b32_dpp v131, v39, v35, vcc quad_perm:[1,0,3,2] row_mask:0xf bank_mask:0xf
    v_mov_b32_dpp v137, v40 quad_perm:[1,0,3,2] row_mask:0xf bank_mask:0xf
    v_cndmask_b32_dpp v135, v47, v43, vcc quad_perm:[1,0,3,2] row_mask:0xf bank_mask:0xf
    s_mov_b64 vcc, s[48:49]
    v_mov_b32_dpp v139, v41 quad_perm:[1,0,3,2] row_mask:0xf bank_mask:0xf
    v_cndmask_b32_dpp v32, v132, v128, vcc quad_perm:[2,3,0,1] row_mask:0xf bank_mask:0xf
    v_cndmask_b32_e64 v44, v137, v44, s[46:47]
    v_cndmask_b32_dpp v33, v133, v129, vcc quad_perm:[2,3,0,1] row_mask:0xf bank_mask:0xf
    v_cndmask_b32_e64 v45, v139, v45, s[46:47]
    s_waitcnt lgkmcnt(4)
    v_mfma_f32_32x32x16_bf16 v[140:155], v[172:175], v[16:19], v[140:155]
    ds_read_b64_tr_b16 v[172:173], v5 offset:2048
    ds_read_b64_tr_b16 v[174:175], v5 offset:2560
    v_cndmask_b32_dpp v34, v134, v130, vcc quad_perm:[2,3,0,1] row_mask:0xf bank_mask:0xf
    v_mov_b32_dpp v137, v42 quad_perm:[1,0,3,2] row_mask:0xf bank_mask:0xf
    v_cndmask_b32_dpp v35, v135, v131, vcc quad_perm:[2,3,0,1] row_mask:0xf bank_mask:0xf
    v_mov_b32_dpp v139, v43 quad_perm:[1,0,3,2] row_mask:0xf bank_mask:0xf
    v_mfma_f32_32x32x16_bf16 v[156:171], v[16:19], v[176:179], v[156:171]
    ds_read_b64_tr_b16 v[176:177], v5 offset:2304
    ds_read_b64_tr_b16 v[178:179], v5 offset:2816
    s_waitcnt lgkmcnt(4)
    buffer_load_dwordx4 v[64:67], v4, s[20:23], s15 offen offset:0
    v_cndmask_b32_e64 v46, v137, v46, s[46:47]
    v_cndmask_b32_e64 v47, v139, v47, s[46:47]
    v_mfma_f32_32x32x16_bf16 v[140:155], v[180:183], v[20:23], v[140:155]
    ds_read_b64_tr_b16 v[180:181], v5 offset:3072
    ds_read_b64_tr_b16 v[182:183], v5 offset:3584
    v_mov_b32_dpp v137, v36 quad_perm:[2,3,0,1] row_mask:0xf bank_mask:0xf
    v_mov_b32_dpp v139, v37 quad_perm:[2,3,0,1] row_mask:0xf bank_mask:0xf
    v_cndmask_b32_e64 v38, v136, v38, s[46:47]
    v_cndmask_b32_e64 v39, v138, v39, s[46:47]
    v_mfma_f32_32x32x16_bf16 v[156:171], v[20:23], v[184:187], v[156:171]
    ds_read_b64_tr_b16 v[184:185], v5 offset:3328
    ds_read_b64_tr_b16 v[186:187], v5 offset:3840
    v_cndmask_b32_dpp v36, v44, v36, vcc quad_perm:[2,3,0,1] row_mask:0xf bank_mask:0xf
    buffer_load_dwordx4 v[68:71], v4, s[20:23], s15 offen offset:896
    v_cndmask_b32_e64 v44, v137, v44, s[50:51]
    v_cndmask_b32_dpp v37, v45, v37, vcc quad_perm:[2,3,0,1] row_mask:0xf bank_mask:0xf
    v_cndmask_b32_e64 v45, v139, v45, s[50:51]
    v_mov_b32_dpp v137, v38 quad_perm:[2,3,0,1] row_mask:0xf bank_mask:0xf
    v_mov_b32_dpp v139, v39 quad_perm:[2,3,0,1] row_mask:0xf bank_mask:0xf
    v_cndmask_b32_dpp v38, v46, v38, vcc quad_perm:[2,3,0,1] row_mask:0xf bank_mask:0xf
    v_mov_b32_dpp v136, v128 quad_perm:[2,3,0,1] row_mask:0xf bank_mask:0xf
    v_cndmask_b32_dpp v39, v47, v39, vcc quad_perm:[2,3,0,1] row_mask:0xf bank_mask:0xf
    v_mov_b32_dpp v138, v129 quad_perm:[2,3,0,1] row_mask:0xf bank_mask:0xf
    s_waitcnt lgkmcnt(4)
    v_mfma_f32_32x32x16_bf16 v[140:155], v[172:175], v[24:27], v[140:155]
    ds_read_b64_tr_b16 v[172:173], v5 offset:8192
    ds_read_b64_tr_b16 v[174:175], v5 offset:8704
    v_cndmask_b32_e64 v40, v136, v132, s[50:51]
    buffer_load_dwordx4 v[72:75], v4, s[20:23], s15 offen offset:1792
    v_cndmask_b32_e64 v41, v138, v133, s[50:51]
    v_mov_b32_dpp v136, v130 quad_perm:[2,3,0,1] row_mask:0xf bank_mask:0xf
    v_mfma_f32_32x32x16_bf16 v[156:171], v[24:27], v[176:179], v[156:171]
    ds_read_b64_tr_b16 v[176:177], v5 offset:8448
    ds_read_b64_tr_b16 v[178:179], v5 offset:8960
    v_cndmask_b32_e64 v46, v137, v46, s[50:51]
    v_mov_b32_dpp v138, v131 quad_perm:[2,3,0,1] row_mask:0xf bank_mask:0xf
    v_cndmask_b32_e64 v47, v139, v47, s[50:51]
    s_waitcnt lgkmcnt(4)
    v_mfma_f32_32x32x16_bf16 v[140:155], v[180:183], v[28:31], v[140:155]
    ds_read_b64_tr_b16 v[180:181], v5 offset:9216
    ds_read_b64_tr_b16 v[182:183], v5 offset:9728
    s_mov_b64 vcc, s[44:45]
    buffer_load_dwordx4 v[76:79], v4, s[20:23], s15 offen offset:2688
    v_cndmask_b32_e64 v42, v136, v134, s[50:51]
    v_cndmask_b32_e64 v43, v138, v135, s[50:51]
    v_mfma_f32_32x32x16_bf16 v[156:171], v[28:31], v[184:187], v[156:171]
    ds_read_b64_tr_b16 v[184:185], v5 offset:9472
    ds_read_b64_tr_b16 v[186:187], v5 offset:9984
    s_add_u32 m0, s62, 32768
    s_mul_i32 s42, s16, 1344
    s_add_u32 s42, s42, s63
    buffer_load_dwordx4 v8, s[64:67], s42 offen lds
    s_waitcnt lgkmcnt(4)
    v_mfma_f32_32x32x16_bf16 v[140:155], v[172:175], v[32:35], v[140:155]
    ds_read_b64_tr_b16 v[172:173], v5 offset:10240
    ds_read_b64_tr_b16 v[174:175], v5 offset:10752
    v_mfma_f32_32x32x16_bf16 v[156:171], v[32:35], v[176:179], v[156:171]
    ds_read_b64_tr_b16 v[176:177], v5 offset:10496
    s_add_u32 m0, s62, 36864
    s_mul_i32 s42, s16, 1344
    s_add_u32 s42, s42, s63
    s_add_u32 s42, s42, 86016
    buffer_load_dwordx4 v8, s[64:67], s42 offen lds
    ds_read_b64_tr_b16 v[178:179], v5 offset:11008
    s_waitcnt lgkmcnt(4)
    v_mfma_f32_32x32x16_bf16 v[140:155], v[180:183], v[36:39], v[140:155]
    s_waitcnt vmcnt(10)
    ds_read_b64_tr_b16 v[180:181], v5 offset:11264
    ds_read_b64_tr_b16 v[182:183], v5 offset:11776
    v_cndmask_b32_dpp v132, v60, v56, vcc quad_perm:[1,0,3,2] row_mask:0xf bank_mask:0xf
    v_mov_b32_dpp v137, v56 quad_perm:[1,0,3,2] row_mask:0xf bank_mask:0xf
    v_cndmask_b32_dpp v133, v61, v57, vcc quad_perm:[1,0,3,2] row_mask:0xf bank_mask:0xf
    v_mfma_f32_32x32x16_bf16 v[156:171], v[36:39], v[184:187], v[156:171]
    ds_read_b64_tr_b16 v[184:185], v5 offset:11520
    ds_read_b64_tr_b16 v[186:187], v5 offset:12032
    buffer_load_dwordx4 v[80:83], v4, s[20:23], s16 offen offset:0
    v_mov_b32_dpp v139, v57 quad_perm:[1,0,3,2] row_mask:0xf bank_mask:0xf
    v_cndmask_b32_dpp v128, v52, v48, vcc quad_perm:[1,0,3,2] row_mask:0xf bank_mask:0xf
    v_mov_b32_dpp v136, v48 quad_perm:[1,0,3,2] row_mask:0xf bank_mask:0xf
    v_cndmask_b32_e64 v60, v137, v60, s[46:47]
    v_cndmask_b32_dpp v129, v53, v49, vcc quad_perm:[1,0,3,2] row_mask:0xf bank_mask:0xf
    v_mov_b32_dpp v138, v49 quad_perm:[1,0,3,2] row_mask:0xf bank_mask:0xf
    v_cndmask_b32_e64 v61, v139, v61, s[46:47]
    v_cndmask_b32_e64 v52, v136, v52, s[46:47]
    v_cndmask_b32_e64 v53, v138, v53, s[46:47]
    v_cndmask_b32_dpp v134, v62, v58, vcc quad_perm:[1,0,3,2] row_mask:0xf bank_mask:0xf
    v_mov_b32_dpp v137, v58 quad_perm:[1,0,3,2] row_mask:0xf bank_mask:0xf
    v_cndmask_b32_dpp v135, v63, v59, vcc quad_perm:[1,0,3,2] row_mask:0xf bank_mask:0xf
    v_mov_b32_dpp v139, v59 quad_perm:[1,0,3,2] row_mask:0xf bank_mask:0xf
    s_waitcnt lgkmcnt(4)
    v_mfma_f32_32x32x16_bf16 v[140:155], v[172:175], v[40:43], v[140:155]
    buffer_load_dwordx4 v[84:87], v4, s[20:23], s16 offen offset:896
    v_cndmask_b32_dpp v130, v54, v50, vcc quad_perm:[1,0,3,2] row_mask:0xf bank_mask:0xf
    v_cndmask_b32_e64 v62, v137, v62, s[46:47]
    v_cndmask_b32_dpp v131, v55, v51, vcc quad_perm:[1,0,3,2] row_mask:0xf bank_mask:0xf
    v_cndmask_b32_e64 v63, v139, v63, s[46:47]
    v_mov_b32_dpp v136, v50 quad_perm:[1,0,3,2] row_mask:0xf bank_mask:0xf
    v_mfma_f32_32x32x16_bf16 v[156:171], v[40:43], v[176:179], v[156:171]
    v_mov_b32_dpp v138, v51 quad_perm:[1,0,3,2] row_mask:0xf bank_mask:0xf
    s_mov_b64 vcc, s[48:49]
    s_waitcnt lgkmcnt(0)
    v_mov_b32_dpp v137, v52 quad_perm:[2,3,0,1] row_mask:0xf bank_mask:0xf
    v_mov_b32_dpp v139, v53 quad_perm:[2,3,0,1] row_mask:0xf bank_mask:0xf
    v_cndmask_b32_e64 v54, v136, v54, s[46:47]
    v_mfma_f32_32x32x16_bf16 v[140:155], v[180:183], v[44:47], v[140:155]
    buffer_load_dwordx4 v[88:91], v4, s[20:23], s16 offen offset:1792
    v_cndmask_b32_e64 v55, v138, v55, s[46:47]
    v_cndmask_b32_dpp v52, v60, v52, vcc quad_perm:[2,3,0,1] row_mask:0xf bank_mask:0xf
    v_mov_b32_dpp v136, v128 quad_perm:[2,3,0,1] row_mask:0xf bank_mask:0xf
    v_cndmask_b32_dpp v53, v61, v53, vcc quad_perm:[2,3,0,1] row_mask:0xf bank_mask:0xf
    v_cndmask_b32_e64 v60, v137, v60, s[50:51]
    v_mfma_f32_32x32x16_bf16 v[156:171], v[44:47], v[184:187], v[156:171]
    v_mov_b32_dpp v138, v129 quad_perm:[2,3,0,1] row_mask:0xf bank_mask:0xf
    v_cndmask_b32_e64 v61, v139, v61, s[50:51]
    v_cndmask_b32_e64 v56, v136, v132, s[50:51]
    v_cndmask_b32_e64 v57, v138, v133, s[50:51]
    v_mov_b32_dpp v137, v54 quad_perm:[2,3,0,1] row_mask:0xf bank_mask:0xf
    v_mov_b32_dpp v139, v55 quad_perm:[2,3,0,1] row_mask:0xf bank_mask:0xf
    v_mov_b32_dpp v136, v130 quad_perm:[2,3,0,1] row_mask:0xf bank_mask:0xf
    v_cndmask_b32_dpp v54, v62, v54, vcc quad_perm:[2,3,0,1] row_mask:0xf bank_mask:0xf
    buffer_load_dwordx4 v[92:95], v4, s[20:23], s16 offen offset:2688
    v_mov_b32_dpp v138, v131 quad_perm:[2,3,0,1] row_mask:0xf bank_mask:0xf
    v_cndmask_b32_dpp v55, v63, v55, vcc quad_perm:[2,3,0,1] row_mask:0xf bank_mask:0xf
    v_cndmask_b32_e64 v58, v136, v134, s[50:51]
    v_cndmask_b32_dpp v48, v132, v128, vcc quad_perm:[2,3,0,1] row_mask:0xf bank_mask:0xf
    v_cndmask_b32_e64 v62, v137, v62, s[50:51]
    v_cndmask_b32_dpp v49, v133, v129, vcc quad_perm:[2,3,0,1] row_mask:0xf bank_mask:0xf
    v_cndmask_b32_e64 v59, v138, v135, s[50:51]
    v_cndmask_b32_dpp v50, v134, v130, vcc quad_perm:[2,3,0,1] row_mask:0xf bank_mask:0xf
    v_cndmask_b32_e64 v63, v139, v63, s[50:51]
    v_cndmask_b32_dpp v51, v135, v131, vcc quad_perm:[2,3,0,1] row_mask:0xf bank_mask:0xf
    s_add_u32 m0, s62, 40960
    s_mul_i32 s42, s17, 1344
    s_add_u32 s42, s42, s63
    buffer_load_dwordx4 v8, s[64:67], s42 offen lds
    s_add_u32 m0, s62, 45056
    s_mul_i32 s42, s17, 1344
    s_add_u32 s42, s42, s63
    s_add_u32 s42, s42, 86016
    buffer_load_dwordx4 v8, s[64:67], s42 offen lds
    s_add_u32 m0, s62, 49152
    s_mul_i32 s42, s18, 1344
    s_add_u32 s42, s42, s63
    buffer_load_dwordx4 v8, s[64:67], s42 offen lds
    s_add_u32 m0, s62, 53248
    s_mul_i32 s42, s18, 1344
    s_add_u32 s42, s42, s63
    s_add_u32 s42, s42, 86016
    buffer_load_dwordx4 v8, s[64:67], s42 offen lds
    s_waitcnt vmcnt(14)
    s_barrier
    ds_read_b64_tr_b16 v[172:173], v5 offset:16384
    ds_read_b64_tr_b16 v[174:175], v5 offset:16896
    ds_read_b64_tr_b16 v[176:177], v5 offset:16640
    ds_read_b64_tr_b16 v[178:179], v5 offset:17152
    ds_read_b64_tr_b16 v[180:181], v5 offset:17408
    ds_read_b64_tr_b16 v[182:183], v5 offset:17920
    ds_read_b64_tr_b16 v[184:185], v5 offset:17664
    ds_read_b64_tr_b16 v[186:187], v5 offset:18176
    s_waitcnt vmcnt(10)
    s_mov_b64 vcc, s[44:45]
    v_cndmask_b32_dpp v128, v68, v64, vcc quad_perm:[1,0,3,2] row_mask:0xf bank_mask:0xf
    v_mov_b32_dpp v136, v64 quad_perm:[1,0,3,2] row_mask:0xf bank_mask:0xf
    v_cndmask_b32_dpp v129, v69, v65, vcc quad_perm:[1,0,3,2] row_mask:0xf bank_mask:0xf
    v_mov_b32_dpp v138, v65 quad_perm:[1,0,3,2] row_mask:0xf bank_mask:0xf
    v_cndmask_b32_dpp v132, v76, v72, vcc quad_perm:[1,0,3,2] row_mask:0xf bank_mask:0xf
    v_cndmask_b32_e64 v68, v136, v68, s[46:47]
    v_cndmask_b32_dpp v133, v77, v73, vcc quad_perm:[1,0,3,2] row_mask:0xf bank_mask:0xf
    v_cndmask_b32_e64 v69, v138, v69, s[46:47]
    v_cndmask_b32_dpp v130, v70, v66, vcc quad_perm:[1,0,3,2] row_mask:0xf bank_mask:0xf
    v_mov_b32_dpp v136, v66 quad_perm:[1,0,3,2] row_mask:0xf bank_mask:0xf
    v_cndmask_b32_dpp v134, v78, v74, vcc quad_perm:[1,0,3,2] row_mask:0xf bank_mask:0xf
    v_mov_b32_dpp v138, v67 quad_perm:[1,0,3,2] row_mask:0xf bank_mask:0xf
    v_cndmask_b32_dpp v131, v71, v67, vcc quad_perm:[1,0,3,2] row_mask:0xf bank_mask:0xf
    v_mov_b32_dpp v137, v72 quad_perm:[1,0,3,2] row_mask:0xf bank_mask:0xf
    v_cndmask_b32_dpp v135, v79, v75, vcc quad_perm:[1,0,3,2] row_mask:0xf bank_mask:0xf
    s_mov_b64 vcc, s[48:49]
    v_mov_b32_dpp v139, v73 quad_perm:[1,0,3,2] row_mask:0xf bank_mask:0xf
    v_cndmask_b32_dpp v64, v132, v128, vcc quad_perm:[2,3,0,1] row_mask:0xf bank_mask:0xf
    v_cndmask_b32_e64 v76, v137, v76, s[46:47]
    v_cndmask_b32_dpp v65, v133, v129, vcc quad_perm:[2,3,0,1] row_mask:0xf bank_mask:0xf
    v_cndmask_b32_e64 v77, v139, v77, s[46:47]
    s_waitcnt lgkmcnt(4)
    v_mfma_f32_32x32x16_bf16 v[140:155], v[172:175], v[48:51], v[140:155]
    ds_read_b64_tr_b16 v[172:173], v5 offset:18432
    ds_read_b64_tr_b16 v[174:175], v5 offset:18944
    v_cndmask_b32_dpp v66, v134, v130, vcc quad_perm:[2,3,0,1] row_mask:0xf bank_mask:0xf
    v_mov_b32_dpp v137, v74 quad_perm:[1,0,3,2] row_mask:0xf bank_mask:0xf
    v_cndmask_b32_dpp v67, v135, v131, vcc quad_perm:[2,3,0,1] row_mask:0xf bank_mask:0xf
    v_mov_b32_dpp v139, v75 quad_perm:[1,0,3,2] row_mask:0xf bank_mask:0xf
    v_mfma_f32_32x32x16_bf16 v[156:171], v[48:51], v[176:179], v[156:171]
    ds_read_b64_tr_b16 v[176:177], v5 offset:18688
    ds_read_b64_tr_b16 v[178:179], v5 offset:19200
    s_waitcnt lgkmcnt(4)
    v_cndmask_b32_e64 v78, v137, v78, s[46:47]
    v_cndmask_b32_e64 v79, v139, v79, s[46:47]
    v_mov_b32_dpp v137, v68 quad_perm:[2,3,0,1] row_mask:0xf bank_mask:0xf
    v_mfma_f32_32x32x16_bf16 v[140:155], v[180:183], v[52:55], v[140:155]
    ds_read_b64_tr_b16 v[180:181], v5 offset:19456
    ds_read_b64_tr_b16 v[182:183], v5 offset:19968
    v_mov_b32_dpp v139, v69 quad_perm:[2,3,0,1] row_mask:0xf bank_mask:0xf
    v_cndmask_b32_e64 v70, v136, v70, s[46:47]
    v_cndmask_b32_e64 v71, v138, v71, s[46:47]
    v_cndmask_b32_dpp v68, v76, v68, vcc quad_perm:[2,3,0,1] row_mask:0xf bank_mask:0xf
    v_mfma_f32_32x32x16_bf16 v[156:171], v[52:55], v[184:187], v[156:171]
    ds_read_b64_tr_b16 v[184:185], v5 offset:19712
    ds_read_b64_tr_b16 v[186:187], v5 offset:20224
    v_cndmask_b32_dpp v69, v77, v69, vcc quad_perm:[2,3,0,1] row_mask:0xf bank_mask:0xf
    v_cndmask_b32_e64 v76, v137, v76, s[50:51]
    v_cndmask_b32_e64 v77, v139, v77, s[50:51]
    v_mov_b32_dpp v137, v70 quad_perm:[2,3,0,1] row_mask:0xf bank_mask:0xf
    v_mov_b32_dpp v139, v71 quad_perm:[2,3,0,1] row_mask:0xf bank_mask:0xf
    buffer_load_dwordx4 v[96:99], v4, s[20:23], s17 offen offset:0
    v_cndmask_b32_dpp v70, v78, v70, vcc quad_perm:[2,3,0,1] row_mask:0xf bank_mask:0xf
    v_mov_b32 v252, 0
    v_cndmask_b32_dpp v71, v79, v71, vcc quad_perm:[2,3,0,1] row_mask:0xf bank_mask:0xf
    v_mov_b32 v204, -1
    v_mov_b32 v205, -1
    s_waitcnt lgkmcnt(4)
    v_mfma_f32_32x32x16_bf16 v[140:155], v[172:175], v[56:59], v[140:155]
    ds_read_b64_tr_b16 v[172:173], v5 offset:24576
    ds_read_b64_tr_b16 v[174:175], v5 offset:25088
    v_mov_b32 v206, -1
    v_mov_b32 v207, -1
    v_mov_b32_dpp v136, v128 quad_perm:[2,3,0,1] row_mask:0xf bank_mask:0xf
    v_mov_b32_dpp v138, v129 quad_perm:[2,3,0,1] row_mask:0xf bank_mask:0xf
    v_mfma_f32_32x32x16_bf16 v[156:171], v[56:59], v[176:179], v[156:171]
    ds_read_b64_tr_b16 v[176:177], v5 offset:24832
    ds_read_b64_tr_b16 v[178:179], v5 offset:25344
    buffer_load_dwordx4 v[100:103], v4, s[20:23], s17 offen offset:896
    v_cndmask_b32_e64 v72, v136, v132, s[50:51]
    v_cndmask_b32_e64 v73, v138, v133, s[50:51]
    s_waitcnt lgkmcnt(4)
    v_mfma_f32_32x32x16_bf16 v[140:155], v[180:183], v[60:63], v[140:155]
    ds_read_b64_tr_b16 v[180:181], v5 offset:25600
    ds_read_b64_tr_b16 v[182:183], v5 offset:26112
    v_mov_b32_dpp v136, v130 quad_perm:[2,3,0,1] row_mask:0xf bank_mask:0xf
    v_cndmask_b32_e64 v78, v137, v78, s[50:51]
    v_mov_b32_dpp v138, v131 quad_perm:[2,3,0,1] row_mask:0xf bank_mask:0xf
    v_cndmask_b32_e64 v79, v139, v79, s[50:51]
    v_mfma_f32_32x32x16_bf16 v[156:171], v[60:63], v[184:187], v[156:171]
    ds_read_b64_tr_b16 v[184:185], v5 offset:25856
    ds_read_b64_tr_b16 v[186:187], v5 offset:26368
    buffer_load_dwordx4 v[104:107], v4, s[20:23], s17 offen offset:1792
    s_mov_b64 vcc, s[44:45]
    v_cndmask_b32_e64 v74, v136, v134, s[50:51]
    v_cndmask_b32_e64 v75, v138, v135, s[50:51]
    s_waitcnt lgkmcnt(4)
    v_mfma_f32_32x32x16_bf16 v[140:155], v[172:175], v[64:67], v[140:155]
    ds_read_b64_tr_b16 v[172:173], v5 offset:26624
    ds_read_b64_tr_b16 v[174:175], v5 offset:27136
    buffer_load_dwordx4 v[108:111], v4, s[20:23], s17 offen offset:2688
    s_waitcnt vmcnt(8)
    v_cndmask_b32_dpp v132, v92, v88, vcc quad_perm:[1,0,3,2] row_mask:0xf bank_mask:0xf
    v_mov_b32_dpp v137, v88 quad_perm:[1,0,3,2] row_mask:0xf bank_mask:0xf
    v_mfma_f32_32x32x16_bf16 v[156:171], v[64:67], v[176:179], v[156:171]
    ds_read_b64_tr_b16 v[176:177], v5 offset:26880
    ds_read_b64_tr_b16 v[178:179], v5 offset:27392
    v_cndmask_b32_dpp v133, v93, v89, vcc quad_perm:[1,0,3,2] row_mask:0xf bank_mask:0xf
    v_mov_b32_dpp v139, v89 quad_perm:[1,0,3,2] row_mask:0xf bank_mask:0xf
    v_cndmask_b32_dpp v128, v84, v80, vcc quad_perm:[1,0,3,2] row_mask:0xf bank_mask:0xf
    s_waitcnt lgkmcnt(4)
    v_mfma_f32_32x32x16_bf16 v[140:155], v[180:183], v[68:71], v[140:155]
    ds_read_b64_tr_b16 v[180:181], v5 offset:27648
    ds_read_b64_tr_b16 v[182:183], v5 offset:28160
    buffer_load_dwordx4 v[112:115], v4, s[20:23], s18 offen offset:0
    v_mov_b32_dpp v136, v80 quad_perm:[1,0,3,2] row_mask:0xf bank_mask:0xf
    v_cndmask_b32_e64 v92, v137, v92, s[46:47]
    v_cndmask_b32_dpp v129, v85, v81, vcc quad_perm:[1,0,3,2] row_mask:0xf bank_mask:0xf
    v_mfma_f32_32x32x16_bf16 v[156:171], v[68:71], v[184:187], v[156:171]
    ds_read_b64_tr_b16 v[184:185], v5 offset:27904
    ds_read_b64_tr_b16 v[186:187], v5 offset:28416
    v_mov_b32_dpp v138, v81 quad_perm:[1,0,3,2] row_mask:0xf bank_mask:0xf
    v_cndmask_b32_e64 v93, v139, v93, s[46:47]
    v_cndmask_b32_e64 v84, v136, v84, s[46:47]
    v_cndmask_b32_e64 v85, v138, v85, s[46:47]
    v_cndmask_b32_dpp v134, v94, v90, vcc quad_perm:[1,0,3,2] row_mask:0xf bank_mask:0xf
    v_mov_b32_dpp v137, v90 quad_perm:[1,0,3,2] row_mask:0xf bank_mask:0xf
    v_cndmask_b32_dpp v135, v95, v91, vcc quad_perm:[1,0,3,2] row_mask:0xf bank_mask:0xf
    v_mov_b32_dpp v139, v91 quad_perm:[1,0,3,2] row_mask:0xf bank_mask:0xf
    buffer_load_dwordx4 v[116:119], v4, s[20:23], s18 offen offset:896
    v_cndmask_b32_dpp v130, v86, v82, vcc quad_perm:[1,0,3,2] row_mask:0xf bank_mask:0xf
    v_cndmask_b32_e64 v94, v137, v94, s[46:47]
    s_waitcnt lgkmcnt(4)
    v_mfma_f32_32x32x16_bf16 v[140:155], v[172:175], v[72:75], v[140:155]
    v_cndmask_b32_dpp v131, v87, v83, vcc quad_perm:[1,0,3,2] row_mask:0xf bank_mask:0xf
    v_cndmask_b32_e64 v95, v139, v95, s[46:47]
    v_mov_b32_dpp v136, v82 quad_perm:[1,0,3,2] row_mask:0xf bank_mask:0xf
    v_mov_b32_dpp v138, v83 quad_perm:[1,0,3,2] row_mask:0xf bank_mask:0xf
    s_mov_b64 vcc, s[48:49]
    v_mov_b32_dpp v137, v84 quad_perm:[2,3,0,1] row_mask:0xf bank_mask:0xf
    v_mfma_f32_32x32x16_bf16 v[156:171], v[72:75], v[176:179], v[156:171]
    v_mov_b32_dpp v139, v85 quad_perm:[2,3,0,1] row_mask:0xf bank_mask:0xf
    v_cndmask_b32_e64 v86, v136, v86, s[46:47]
    buffer_load_dwordx4 v[120:123], v4, s[20:23], s18 offen offset:1792
    v_cndmask_b32_e64 v87, v138, v87, s[46:47]
    v_cndmask_b32_dpp v84, v92, v84, vcc quad_perm:[2,3,0,1] row_mask:0xf bank_mask:0xf
    s_waitcnt lgkmcnt(0)
    v_mfma_f32_32x32x16_bf16 v[140:155], v[180:183], v[76:79], v[140:155]
    v_cndmask_b32_dpp v85, v93, v85, vcc quad_perm:[2,3,0,1] row_mask:0xf bank_mask:0xf
    v_mov_b32_dpp v136, v128 quad_perm:[2,3,0,1] row_mask:0xf bank_mask:0xf
    v_cndmask_b32_e64 v92, v137, v92, s[50:51]
    v_mov_b32_dpp v138, v129 quad_perm:[2,3,0,1] row_mask:0xf bank_mask:0xf
    v_cndmask_b32_e64 v93, v139, v93, s[50:51]
    v_cndmask_b32_e64 v88, v136, v132, s[50:51]
    v_mfma_f32_32x32x16_bf16 v[156:171], v[76:79], v[184:187], v[156:171]
    v_cndmask_b32_e64 v89, v138, v133, s[50:51]
    v_mov_b32_dpp v137, v86 quad_perm:[2,3,0,1] row_mask:0xf bank_mask:0xf
    buffer_load_dwordx4 v[124:127], v4, s[20:23], s18 offen offset:2688
    v_mov_b32_dpp v139, v87 quad_perm:[2,3,0,1] row_mask:0xf bank_mask:0xf
    v_mov_b32_dpp v136, v130 quad_perm:[2,3,0,1] row_mask:0xf bank_mask:0xf
    v_cndmask_b32_dpp v86, v94, v86, vcc quad_perm:[2,3,0,1] row_mask:0xf bank_mask:0xf
    v_mov_b32_dpp v138, v131 quad_perm:[2,3,0,1] row_mask:0xf bank_mask:0xf
    v_cndmask_b32_dpp v87, v95, v87, vcc quad_perm:[2,3,0,1] row_mask:0xf bank_mask:0xf
    v_cndmask_b32_e64 v90, v136, v134, s[50:51]
    v_cndmask_b32_dpp v80, v132, v128, vcc quad_perm:[2,3,0,1] row_mask:0xf bank_mask:0xf
    v_cndmask_b32_e64 v94, v137, v94, s[50:51]
    v_cndmask_b32_dpp v81, v133, v129, vcc quad_perm:[2,3,0,1] row_mask:0xf bank_mask:0xf
    v_cndmask_b32_e64 v91, v138, v135, s[50:51]
    v_cndmask_b32_dpp v82, v134, v130, vcc quad_perm:[2,3,0,1] row_mask:0xf bank_mask:0xf
    v_cndmask_b32_e64 v95, v139, v95, s[50:51]
    v_cndmask_b32_dpp v83, v135, v131, vcc quad_perm:[2,3,0,1] row_mask:0xf bank_mask:0xf
    s_and_b32 s39, s34, 1
    s_lshl_b32 s39, s39, 10
    s_add_u32 m0, s39, 4096
    s_mul_i32 s40, s33, 1568
    s_add_u32 s40, s40, s39
    v_lshlrev_b32 v2, 4, v1
    buffer_load_dwordx4 v2, s[68:71], s40 offen lds
    s_lshl_b32 s39, s33, 4
    s_add_u32 s39, s39, s32
    s_lshl_b32 s39, s39, 12
    s_add_u32 s39, s39, s62
    s_add_u32 s39, s39, 1048576
    v_lshl_add_u32 v253, v1, 4, s39
    s_lshl_b32 s39, s32, 2
    s_add_u32 s39, s39, s34
    s_lshl_b32 s39, s39, 4
    global_load_dword v252, v252, s[28:29] sc1
    s_add_u32 s39, s39, s33
    s_lshl_b32 s39, s39, 11
    s_add_u32 s39, s39, 2097152
    v_lshl_add_u32 v254, v1, 4, s39
    global_store_dwordx4 v253, v[204:207], s[30:31] sc1
    s_waitcnt vmcnt(11)
    s_barrier
    ds_read_b64_tr_b16 v[172:173], v5 offset:32768
    ds_read_b64_tr_b16 v[174:175], v5 offset:33280
    ds_read_b64_tr_b16 v[176:177], v5 offset:33024
    ds_read_b64_tr_b16 v[178:179], v5 offset:33536
    ds_read_b64_tr_b16 v[180:181], v5 offset:33792
    ds_read_b64_tr_b16 v[182:183], v5 offset:34304
    ds_read_b64_tr_b16 v[184:185], v5 offset:34048
    ds_read_b64_tr_b16 v[186:187], v5 offset:34560
    s_waitcnt vmcnt(7)
    s_mov_b64 vcc, s[44:45]
    v_cndmask_b32_dpp v128, v100, v96, vcc quad_perm:[1,0,3,2] row_mask:0xf bank_mask:0xf
    v_mov_b32_dpp v136, v96 quad_perm:[1,0,3,2] row_mask:0xf bank_mask:0xf
    v_cndmask_b32_dpp v129, v101, v97, vcc quad_perm:[1,0,3,2] row_mask:0xf bank_mask:0xf
    v_mov_b32_dpp v138, v97 quad_perm:[1,0,3,2] row_mask:0xf bank_mask:0xf
    v_cndmask_b32_dpp v132, v108, v104, vcc quad_perm:[1,0,3,2] row_mask:0xf bank_mask:0xf
    v_cndmask_b32_e64 v100, v136, v100, s[46:47]
    v_cndmask_b32_dpp v133, v109, v105, vcc quad_perm:[1,0,3,2] row_mask:0xf bank_mask:0xf
    v_cndmask_b32_e64 v101, v138, v101, s[46:47]
    v_cndmask_b32_dpp v130, v102, v98, vcc quad_perm:[1,0,3,2] row_mask:0xf bank_mask:0xf
    v_mov_b32_dpp v137, v104 quad_perm:[1,0,3,2] row_mask:0xf bank_mask:0xf
    v_cndmask_b32_dpp v134, v110, v106, vcc quad_perm:[1,0,3,2] row_mask:0xf bank_mask:0xf
    v_mov_b32_dpp v139, v105 quad_perm:[1,0,3,2] row_mask:0xf bank_mask:0xf
    v_cndmask_b32_dpp v131, v103, v99, vcc quad_perm:[1,0,3,2] row_mask:0xf bank_mask:0xf
    v_mov_b32_dpp v136, v98 quad_perm:[1,0,3,2] row_mask:0xf bank_mask:0xf
    v_cndmask_b32_dpp v135, v111, v107, vcc quad_perm:[1,0,3,2] row_mask:0xf bank_mask:0xf
    v_mov_b32_dpp v138, v99 quad_perm:[1,0,3,2] row_mask:0xf bank_mask:0xf
    s_mov_b64 vcc, s[48:49]
    v_cndmask_b32_e64 v108, v137, v108, s[46:47]
    v_cndmask_b32_e64 v109, v139, v109, s[46:47]
    v_cndmask_b32_dpp v96, v132, v128, vcc quad_perm:[2,3,0,1] row_mask:0xf bank_mask:0xf
    v_mov_b32_dpp v137, v106 quad_perm:[1,0,3,2] row_mask:0xf bank_mask:0xf
    s_waitcnt lgkmcnt(4)
    v_mfma_f32_32x32x16_bf16 v[140:155], v[172:175], v[80:83], v[140:155]
    ds_read_b64_tr_b16 v[172:173], v5 offset:34816
    ds_read_b64_tr_b16 v[174:175], v5 offset:35328
    v_cndmask_b32_dpp v97, v133, v129, vcc quad_perm:[2,3,0,1] row_mask:0xf bank_mask:0xf
    v_mov_b32_dpp v139, v107 quad_perm:[1,0,3,2] row_mask:0xf bank_mask:0xf
    v_cndmask_b32_dpp v98, v134, v130, vcc quad_perm:[2,3,0,1] row_mask:0xf bank_mask:0xf
    v_cndmask_b32_e64 v110, v137, v110, s[46:47]
    v_mfma_f32_32x32x16_bf16 v[156:171], v[80:83], v[176:179], v[156:171]
    ds_read_b64_tr_b16 v[176:177], v5 offset:35072
    ds_read_b64_tr_b16 v[178:179], v5 offset:35584
    s_waitcnt lgkmcnt(4)
    v_cndmask_b32_dpp v99, v135, v131, vcc quad_perm:[2,3,0,1] row_mask:0xf bank_mask:0xf
    v_cndmask_b32_e64 v111, v139, v111, s[46:47]
    v_mov_b32_dpp v137, v100 quad_perm:[2,3,0,1] row_mask:0xf bank_mask:0xf
    v_mfma_f32_32x32x16_bf16 v[140:155], v[180:183], v[84:87], v[140:155]
    ds_read_b64_tr_b16 v[180:181], v5 offset:35840
    ds_read_b64_tr_b16 v[182:183], v5 offset:36352
    v_mov_b32_dpp v139, v101 quad_perm:[2,3,0,1] row_mask:0xf bank_mask:0xf
    v_cndmask_b32_e64 v102, v136, v102, s[46:47]
    v_cndmask_b32_e64 v103, v138, v103, s[46:47]
    v_cndmask_b32_dpp v100, v108, v100, vcc quad_perm:[2,3,0,1] row_mask:0xf bank_mask:0xf
    v_mfma_f32_32x32x16_bf16 v[156:171], v[84:87], v[184:187], v[156:171]
    ds_read_b64_tr_b16 v[184:185], v5 offset:36096
    ds_read_b64_tr_b16 v[186:187], v5 offset:36608
    v_cndmask_b32_dpp v101, v109, v101, vcc quad_perm:[2,3,0,1] row_mask:0xf bank_mask:0xf
    v_cndmask_b32_e64 v108, v137, v108, s[50:51]
    v_cndmask_b32_e64 v109, v139, v109, s[50:51]
    v_mov_b32_dpp v137, v102 quad_perm:[2,3,0,1] row_mask:0xf bank_mask:0xf
    v_mov_b32_dpp v139, v103 quad_perm:[2,3,0,1] row_mask:0xf bank_mask:0xf
    v_cndmask_b32_dpp v102, v110, v102, vcc quad_perm:[2,3,0,1] row_mask:0xf bank_mask:0xf
    s_waitcnt vmcnt(3)
    v_mov_b32_dpp v136, v128 quad_perm:[2,3,0,1] row_mask:0xf bank_mask:0xf
    v_cndmask_b32_dpp v103, v111, v103, vcc quad_perm:[2,3,0,1] row_mask:0xf bank_mask:0xf
    v_mov_b32_dpp v138, v129 quad_perm:[2,3,0,1] row_mask:0xf bank_mask:0xf
    v_cndmask_b32_e64 v104, v136, v132, s[50:51]
    s_waitcnt lgkmcnt(4)
    v_mfma_f32_32x32x16_bf16 v[140:155], v[172:175], v[88:91], v[140:155]
    ds_read_b64_tr_b16 v[172:173], v5 offset:40960
    ds_read_b64_tr_b16 v[174:175], v5 offset:41472
    v_cndmask_b32_e64 v105, v138, v133, s[50:51]
    v_mov_b32_dpp v136, v130 quad_perm:[2,3,0,1] row_mask:0xf bank_mask:0xf
    v_mov_b32_dpp v138, v131 quad_perm:[2,3,0,1] row_mask:0xf bank_mask:0xf
    v_cndmask_b32_e64 v106, v136, v134, s[50:51]
    v_mfma_f32_32x32x16_bf16 v[156:171], v[88:91], v[176:179], v[156:171]
    ds_read_b64_tr_b16 v[176:177], v5 offset:41216
    ds_read_b64_tr_b16 v[178:179], v5 offset:41728
    v_cndmask_b32_e64 v107, v138, v135, s[50:51]
    v_cndmask_b32_e64 v110, v137, v110, s[50:51]
    v_cndmask_b32_e64 v111, v139, v111, s[50:51]
    s_waitcnt lgkmcnt(4)
    v_mfma_f32_32x32x16_bf16 v[140:155], v[180:183], v[92:95], v[140:155]
    ds_read_b64_tr_b16 v[180:181], v5 offset:41984
    ds_read_b64_tr_b16 v[182:183], v5 offset:42496
    s_mov_b64 vcc, s[44:45]
    v_cndmask_b32_dpp v128, v116, v112, vcc quad_perm:[1,0,3,2] row_mask:0xf bank_mask:0xf
    v_mov_b32_dpp v136, v112 quad_perm:[1,0,3,2] row_mask:0xf bank_mask:0xf
    v_cndmask_b32_dpp v129, v117, v113, vcc quad_perm:[1,0,3,2] row_mask:0xf bank_mask:0xf
    v_mfma_f32_32x32x16_bf16 v[156:171], v[92:95], v[184:187], v[156:171]
    ds_read_b64_tr_b16 v[184:185], v5 offset:42240
    ds_read_b64_tr_b16 v[186:187], v5 offset:42752
    v_mov_b32_dpp v138, v113 quad_perm:[1,0,3,2] row_mask:0xf bank_mask:0xf
    v_cndmask_b32_dpp v132, v124, v120, vcc quad_perm:[1,0,3,2] row_mask:0xf bank_mask:0xf
    v_cndmask_b32_e64 v116, v136, v116, s[46:47]
    v_cndmask_b32_dpp v133, v125, v121, vcc quad_perm:[1,0,3,2] row_mask:0xf bank_mask:0xf
    v_cndmask_b32_e64 v117, v138, v117, s[46:47]
    v_cndmask_b32_dpp v130, v118, v114, vcc quad_perm:[1,0,3,2] row_mask:0xf bank_mask:0xf
    v_mov_b32_dpp v137, v120 quad_perm:[1,0,3,2] row_mask:0xf bank_mask:0xf
    v_cndmask_b32_dpp v134, v126, v122, vcc quad_perm:[1,0,3,2] row_mask:0xf bank_mask:0xf
    v_mov_b32_dpp v139, v121 quad_perm:[1,0,3,2] row_mask:0xf bank_mask:0xf
    v_cndmask_b32_dpp v131, v119, v115, vcc quad_perm:[1,0,3,2] row_mask:0xf bank_mask:0xf
    v_mov_b32_dpp v136, v114 quad_perm:[1,0,3,2] row_mask:0xf bank_mask:0xf
    s_waitcnt lgkmcnt(4)
    v_mfma_f32_32x32x16_bf16 v[140:155], v[172:175], v[96:99], v[140:155]
    ds_read_b64_tr_b16 v[172:173], v5 offset:43008
    ds_read_b64_tr_b16 v[174:175], v5 offset:43520
    v_cndmask_b32_dpp v135, v127, v123, vcc quad_perm:[1,0,3,2] row_mask:0xf bank_mask:0xf
    v_mov_b32_dpp v138, v115 quad_perm:[1,0,3,2] row_mask:0xf bank_mask:0xf
    s_mov_b64 vcc, s[48:49]
    v_cndmask_b32_e64 v124, v137, v124, s[46:47]
    v_mfma_f32_32x32x16_bf16 v[156:171], v[96:99], v[176:179], v[156:171]
    ds_read_b64_tr_b16 v[176:177], v5 offset:43264
    ds_read_b64_tr_b16 v[178:179], v5 offset:43776
    v_cndmask_b32_e64 v125, v139, v125, s[46:47]
    v_cndmask_b32_dpp v112, v132, v128, vcc quad_perm:[2,3,0,1] row_mask:0xf bank_mask:0xf
    v_mov_b32_dpp v137, v122 quad_perm:[1,0,3,2] row_mask:0xf bank_mask:0xf
    s_waitcnt lgkmcnt(4)
    v_mfma_f32_32x32x16_bf16 v[140:155], v[180:183], v[100:103], v[140:155]
    ds_read_b64_tr_b16 v[180:181], v5 offset:44032
    ds_read_b64_tr_b16 v[182:183], v5 offset:44544
    v_cndmask_b32_dpp v113, v133, v129, vcc quad_perm:[2,3,0,1] row_mask:0xf bank_mask:0xf
    v_mov_b32_dpp v139, v123 quad_perm:[1,0,3,2] row_mask:0xf bank_mask:0xf
    v_cndmask_b32_dpp v114, v134, v130, vcc quad_perm:[2,3,0,1] row_mask:0xf bank_mask:0xf
    v_cndmask_b32_e64 v126, v137, v126, s[46:47]
    v_mfma_f32_32x32x16_bf16 v[156:171], v[100:103], v[184:187], v[156:171]
    ds_read_b64_tr_b16 v[184:185], v5 offset:44288
    ds_read_b64_tr_b16 v[186:187], v5 offset:44800
    v_cndmask_b32_dpp v115, v135, v131, vcc quad_perm:[2,3,0,1] row_mask:0xf bank_mask:0xf
    v_cndmask_b32_e64 v127, v139, v127, s[46:47]
    v_mov_b32_dpp v137, v116 quad_perm:[2,3,0,1] row_mask:0xf bank_mask:0xf
    v_mov_b32_dpp v139, v117 quad_perm:[2,3,0,1] row_mask:0xf bank_mask:0xf
    v_cndmask_b32_e64 v118, v136, v118, s[46:47]
    v_cndmask_b32_e64 v119, v138, v119, s[46:47]
    v_cndmask_b32_dpp v116, v124, v116, vcc quad_perm:[2,3,0,1] row_mask:0xf bank_mask:0xf
    v_cndmask_b32_e64 v124, v137, v124, s[50:51]
    v_cndmask_b32_dpp v117, v125, v117, vcc quad_perm:[2,3,0,1] row_mask:0xf bank_mask:0xf
    v_cndmask_b32_e64 v125, v139, v125, s[50:51]
    v_mov_b32_dpp v137, v118 quad_perm:[2,3,0,1] row_mask:0xf bank_mask:0xf
    s_waitcnt lgkmcnt(4)
    v_mfma_f32_32x32x16_bf16 v[140:155], v[172:175], v[104:107], v[140:155]
    ds_read_b64_tr_b16 v[172:173], v5 offset:49152
    ds_read_b64_tr_b16 v[174:175], v5 offset:49664
    v_mov_b32_dpp v139, v119 quad_perm:[2,3,0,1] row_mask:0xf bank_mask:0xf
    v_cndmask_b32_dpp v118, v126, v118, vcc quad_perm:[2,3,0,1] row_mask:0xf bank_mask:0xf
    v_mov_b32_dpp v136, v128 quad_perm:[2,3,0,1] row_mask:0xf bank_mask:0xf
    v_cndmask_b32_dpp v119, v127, v119, vcc quad_perm:[2,3,0,1] row_mask:0xf bank_mask:0xf
    v_mfma_f32_32x32x16_bf16 v[156:171], v[104:107], v[176:179], v[156:171]
    ds_read_b64_tr_b16 v[176:177], v5 offset:49408
    ds_read_b64_tr_b16 v[178:179], v5 offset:49920
    v_mov_b32_dpp v138, v129 quad_perm:[2,3,0,1] row_mask:0xf bank_mask:0xf
    v_cndmask_b32_e64 v120, v136, v132, s[50:51]
    v_cndmask_b32_e64 v121, v138, v133, s[50:51]
    s_waitcnt lgkmcnt(4)
    v_mfma_f32_32x32x16_bf16 v[140:155], v[180:183], v[108:111], v[140:155]
    ds_read_b64_tr_b16 v[180:181], v5 offset:50176
    ds_read_b64_tr_b16 v[182:183], v5 offset:50688
    v_mov_b32_dpp v136, v130 quad_perm:[2,3,0,1] row_mask:0xf bank_mask:0xf
    v_mov_b32_dpp v138, v131 quad_perm:[2,3,0,1] row_mask:0xf bank_mask:0xf
    v_cndmask_b32_e64 v122, v136, v134, s[50:51]
    v_cndmask_b32_e64 v123, v138, v135, s[50:51]
    v_mfma_f32_32x32x16_bf16 v[156:171], v[108:111], v[184:187], v[156:171]
    ds_read_b64_tr_b16 v[184:185], v5 offset:50432
    ds_read_b64_tr_b16 v[186:187], v5 offset:50944
    v_cndmask_b32_e64 v126, v137, v126, s[50:51]
    v_cndmask_b32_e64 v127, v139, v127, s[50:51]
    s_waitcnt lgkmcnt(4)
    v_mfma_f32_32x32x16_bf16 v[140:155], v[172:175], v[112:115], v[140:155]
    ds_read_b64_tr_b16 v[172:173], v5 offset:51200
    ds_read_b64_tr_b16 v[174:175], v5 offset:51712
    v_mfma_f32_32x32x16_bf16 v[156:171], v[112:115], v[176:179], v[156:171]
    ds_read_b64_tr_b16 v[176:177], v5 offset:51456
    ds_read_b64_tr_b16 v[178:179], v5 offset:51968
    s_waitcnt lgkmcnt(4)
    v_mfma_f32_32x32x16_bf16 v[140:155], v[180:183], v[116:119], v[140:155]
    ds_read_b64_tr_b16 v[180:181], v5 offset:52224
    ds_read_b64_tr_b16 v[182:183], v5 offset:52736
    v_mfma_f32_32x32x16_bf16 v[156:171], v[116:119], v[184:187], v[156:171]
    ds_read_b64_tr_b16 v[184:185], v5 offset:52480
    ds_read_b64_tr_b16 v[186:187], v5 offset:52992
    s_waitcnt lgkmcnt(4)
    v_mfma_f32_32x32x16_bf16 v[140:155], v[172:175], v[120:123], v[140:155]
    v_mfma_f32_32x32x16_bf16 v[156:171], v[120:123], v[176:179], v[156:171]
    s_waitcnt lgkmcnt(0)
    v_mfma_f32_32x32x16_bf16 v[140:155], v[180:183], v[124:127], v[140:155]
    v_mfma_f32_32x32x16_bf16 v[156:171], v[124:127], v[184:187], v[156:171]
    s_setprio 2
    s_waitcnt vmcnt(0)
    s_barrier
    s_cmp_eq_u32 s34, 0
    s_cbranch_scc0 L_A_nopub
    v_mov_b32 v3, 0
    s_mov_b32 s60, 0
L_flAgate:
    v_cmp_ne_u32 vcc, 1, v252
    s_nop 0
    s_cmp_eq_u64 vcc, 0
    s_cbranch_scc1 L_flokAgate
    s_add_u32 s60, s60, 1
    s_cmp_gt_u32 s60, 30000
    s_cbranch_scc1 L_flokAgate
    global_load_dword v252, v3, s[28:29] sc1
    s_waitcnt vmcnt(0)
    s_branch L_flAgate
L_flokAgate:
    s_lshl_b32 s39, s33, 7
    s_lshl_b32 s40, s32, 2
    s_add_u32 s39, s39, s40
    s_add_u32 s39, s39, 0
    v_mov_b32 v2, s39
    s_lshl_b32 s39, s32, 7
    s_lshl_b32 s40, s33, 2
    s_add_u32 s39, s39, s40
    s_add_u32 s39, s39, 2048
    v_mov_b32 v3, s39
    v_mov_b32 v14, 1
    s_mov_b64 exec, 1
    global_store_dword v2, v14, s[30:31] sc1
    s_mov_b64 exec, -1
L_A_nopub:
    ds_read_b64_tr_b16 v[188:189], v12 offset:0
    ds_read_b64_tr_b16 v[190:191], v12 offset:448
    ds_read_b64_tr_b16 v[192:193], v12 offset:896
    ds_read_b64_tr_b16 v[194:195], v12 offset:1344
    s_nop 1
    v_cvt_pk_bf16_f32 v172, v140, v141
    v_cvt_pk_bf16_f32 v173, v142, v143
    v_cvt_pk_bf16_f32 v174, v144, v145
    v_cvt_pk_bf16_f32 v175, v146, v147
    v_cvt_pk_bf16_f32 v178, v152, v153
    v_cvt_pk_bf16_f32 v179, v154, v155
    v_cvt_pk_bf16_f32 v176, v148, v149
    v_cvt_pk_bf16_f32 v177, v150, v151
    v_cndmask_b32_e64 v178, v178, 0, s[52:53]
    v_cndmask_b32_e64 v179, v179, 0, s[52:53]
    v_mov_b32 v129, 0x7f800000
    v_mov_b32 v128, 0xff800000
    s_add_u32 m0, s62, 57344
    s_mul_i32 s42, s12, 1344
    s_add_u32 s42, s42, s19
    buffer_load_dwordx4 v9, s[64:67], s42 offen lds
    v_and_b32 v2, 31, v1
    v_cmp_eq_u32 s[40:41], 28, v2
    v_mov_b32 v3, 0x3f803f80
    v_cvt_pk_bf16_f32 v140, v156, v157
    v_cndmask_b32_e64 v3, 0, v3, s[40:41]
    v_cvt_pk_bf16_f32 v141, v158, v159
    v_cvt_pk_bf16_f32 v142, v160, v161
    v_cvt_pk_bf16_f32 v143, v162, v163
    v_cndmask_b32_e64 v140, v140, v3, s[54:55]
    v_cndmask_b32_e64 v141, v141, v3, s[54:55]
    v_cndmask_b32_e64 v142, v142, v3, s[54:55]
    s_waitcnt lgkmcnt(0)
    v_mfma_f32_32x32x16_bf16 v[204:219], v[188:191], v[172:175], 0
    v_cndmask_b32_e64 v143, v143, v3, s[54:55]
    v_cvt_pk_bf16_f32 v144, v164, v165
    v_cvt_pk_bf16_f32 v145, v166, v167
    v_cvt_pk_bf16_f32 v146, v168, v169
    v_cvt_pk_bf16_f32 v147, v170, v171
    v_cndmask_b32_e64 v144, v144, v3, s[54:55]
    v_mfma_f32_32x32x16_bf16 v[204:219], v[192:195], v[176:179], v[204:219]
    s_add_u32 m0, s62, 61440
    s_mul_i32 s42, s13, 1344
    s_add_u32 s42, s42, s19
    buffer_load_dwordx4 v9, s[64:67], s42 offen lds
    v_cndmask_b32_e64 v145, v145, v3, s[54:55]
    v_cndmask_b32_e64 v146, v146, v3, s[54:55]
    v_cndmask_b32_e64 v147, v147, v3, s[54:55]
    s_nop 4
    v_min3_f32 v132, v204, v205, v206
    v_max3_f32 v130, v204, v205, v206
    v_min3_f32 v135, v207, v208, v209
    v_min3_f32 v132, v132, v210, v211
    v_cndmask_b32_e64 v184, v216, v129, s[52:53]
    v_cndmask_b32_e64 v185, v217, v129, s[52:53]
    v_cndmask_b32_e64 v186, v218, v129, s[52:53]
    v_cndmask_b32_e64 v187, v219, v129, s[52:53]
    v_max3_f32 v134, v207, v208, v209
    v_max3_f32 v130, v130, v210, v211
    v_min3_f32 v135, v135, v212, v213
    v_min3_f32 v132, v132, v214, v215
    v_cndmask_b32_e64 v180, v216, v128, s[52:53]
    v_cndmask_b32_e64 v181, v217, v128, s[52:53]
    v_cndmask_b32_e64 v182, v218, v128, s[52:53]
    v_cndmask_b32_e64 v183, v219, v128, s[52:53]
    v_max3_f32 v134, v134, v212, v213
    v_max3_f32 v130, v130, v214, v215
    v_min3_f32 v135, v135, v184, v185
    v_min3_f32 v132, v132, v186, v187
    v_max3_f32 v134, v134, v180, v181
    v_max3_f32 v130, v130, v182, v183
    v_min_f32 v132, v132, v135
    v_max_f32 v130, v130, v134
    v_mov_b32 v135, v132
    v_mov_b32 v134, v130
    s_add_u32 m0, s62, 65536
    s_mul_i32 s42, s14, 1344
    s_add_u32 s42, s42, s19
    buffer_load_dwordx4 v9, s[64:67], s42 offen lds
    v_permlane32_swap_b32 v132, v135
    v_permlane32_swap_b32 v130, v134
    v_min_f32 v132, v132, v135
    v_max_f32 v130, v130, v134
    v_mul_f32 v132, 0x3fb8aa3b, v132
    v_mul_f32 v130, 0xbfb8aa3b, v130
    v_pk_fma_f32 v[220:221], v[204:205], s[56:57], v[132:133] op_sel_hi:[1,1,0] neg_lo:[1,0,0] neg_hi:[1,0,0]
    v_pk_fma_f32 v[222:223], v[206:207], s[56:57], v[132:133] op_sel_hi:[1,1,0] neg_lo:[1,0,0] neg_hi:[1,0,0]
    v_pk_fma_f32 v[224:225], v[208:209], s[56:57], v[132:133] op_sel_hi:[1,1,0] neg_lo:[1,0,0] neg_hi:[1,0,0]
    v_pk_fma_f32 v[204:205], v[204:205], s[56:57], v[130:131] op_sel_hi:[1,1,0]
    v_pk_fma_f32 v[206:207], v[206:207], s[56:57], v[130:131] op_sel_hi:[1,1,0]
    v_pk_fma_f32 v[226:227], v[210:211], s[56:57], v[132:133] op_sel_hi:[1,1,0] neg_lo:[1,0,0] neg_hi:[1,0,0]
    v_pk_fma_f32 v[208:209], v[208:209], s[56:57], v[130:131] op_sel_hi:[1,1,0]
    v_exp_f32 v204, v204
    v_exp_f32 v205, v205
    v_exp_f32 v206, v206
    v_exp_f32 v207, v207
    v_pk_fma_f32 v[228:229], v[212:213], s[56:57], v[132:133] op_sel_hi:[1,1,0] neg_lo:[1,0,0] neg_hi:[1,0,0]
    v_pk_fma_f32 v[210:211], v[210:211], s[56:57], v[130:131] op_sel_hi:[1,1,0]
    v_exp_f32 v208, v208
    v_exp_f32 v209, v209
    v_pk_fma_f32 v[230:231], v[214:215], s[56:57], v[132:133] op_sel_hi:[1,1,0] neg_lo:[1,0,0] neg_hi:[1,0,0]
    v_pk_fma_f32 v[212:213], v[212:213], s[56:57], v[130:131] op_sel_hi:[1,1,0]
    v_exp_f32 v210, v210
    v_exp_f32 v211, v211
    v_pk_add_f32 v[136:137], v[204:205], v[206:207]
    v_exp_f32 v220, v220
    v_exp_f32 v221, v221
    v_exp_f32 v222, v222
    v_exp_f32 v223, v223
    v_pk_fma_f32 v[214:215], v[214:215], s[56:57], v[130:131] op_sel_hi:[1,1,0]
    v_exp_f32 v212, v212
    v_exp_f32 v213, v213
    v_pk_add_f32 v[136:137], v[136:137], v[208:209]
    v_exp_f32 v224, v224
    v_exp_f32 v225, v225
    v_pk_fma_f32 v[216:217], v[180:181], s[56:57], v[130:131] op_sel_hi:[1,1,0]
    v_exp_f32 v214, v214
    v_exp_f32 v215, v215
    v_pk_add_f32 v[136:137], v[136:137], v[210:211]
    v_exp_f32 v226, v226
    v_exp_f32 v227, v227
    v_pk_add_f32 v[138:139], v[220:221], v[222:223]
    v_pk_fma_f32 v[218:219], v[182:183], s[56:57], v[130:131] op_sel_hi:[1,1,0]
    v_exp_f32 v216, v216
    v_exp_f32 v217, v217
    v_pk_add_f32 v[136:137], v[136:137], v[212:213]
    v_exp_f32 v228, v228
    v_exp_f32 v229, v229
    v_pk_add_f32 v[138:139], v[138:139], v[224:225]
    v_pk_fma_f32 v[232:233], v[184:185], s[56:57], v[132:133] op_sel_hi:[1,1,0] neg_lo:[1,0,0] neg_hi:[1,0,0]
    v_exp_f32 v218, v218
    v_exp_f32 v219, v219
    v_pk_add_f32 v[136:137], v[136:137], v[214:215]
    v_exp_f32 v230, v230
    v_exp_f32 v231, v231
    v_pk_add_f32 v[138:139], v[138:139], v[226:227]
    v_pk_fma_f32 v[234:235], v[186:187], s[56:57], v[132:133] op_sel_hi:[1,1,0] neg_lo:[1,0,0] neg_hi:[1,0,0]
    v_pk_add_f32 v[136:137], v[136:137], v[216:217]
    v_exp_f32 v232, v232
    v_exp_f32 v233, v233
    v_pk_add_f32 v[138:139], v[138:139], v[228:229]
    v_pk_add_f32 v[136:137], v[136:137], v[218:219]
    v_exp_f32 v234, v234
    v_exp_f32 v235, v235
    v_pk_add_f32 v[138:139], v[138:139], v[230:231]
    v_add_f32 v136, v136, v137
    v_pk_add_f32 v[138:139], v[138:139], v[232:233]
    v_mov_b32 v137, v136
    v_pk_add_f32 v[138:139], v[138:139], v[234:235]
    v_add_f32 v138, v138, v139
    v_permlane32_swap_b32 v136, v137
    v_mov_b32 v139, v138
    s_add_u32 m0, s62, 69632
    s_mul_i32 s42, s15, 1344
    s_add_u32 s42, s42, s19
    buffer_load_dwordx4 v9, s[64:67], s42 offen lds
    v_add_f32 v136, v136, v137
    v_permlane32_swap_b32 v138, v139
    v_rcp_f32 v136, v136
    v_add_f32 v138, v138, v139
    v_pk_mul_f32 v[204:205], v[204:205], v[136:137] op_sel_hi:[1,0]
    v_pk_mul_f32 v[206:207], v[206:207], v[136:137] op_sel_hi:[1,0]
    v_pk_mul_f32 v[208:209], v[208:209], v[136:137] op_sel_hi:[1,0]
    v_pk_mul_f32 v[210:211], v[210:211], v[136:137] op_sel_hi:[1,0]
    v_rcp_f32 v138, v138
    v_pk_mul_f32 v[212:213], v[212:213], v[136:137] op_sel_hi:[1,0]
    v_pk_mul_f32 v[214:215], v[214:215], v[136:137] op_sel_hi:[1,0]
    v_pk_mul_f32 v[216:217], v[216:217], v[136:137] op_sel_hi:[1,0]
    v_pk_mul_f32 v[218:219], v[218:219], v[136:137] op_sel_hi:[1,0]
    v_cvt_pk_bf16_f32 v236, v204, v205
    v_cvt_pk_bf16_f32 v237, v206, v207
    v_cvt_pk_bf16_f32 v238, v208, v209
    v_cvt_pk_bf16_f32 v239, v210, v211
    v_cvt_pk_bf16_f32 v240, v212, v213
    s_add_u32 m0, s62, 73728
    s_mul_i32 s42, s16, 1344
    s_add_u32 s42, s42, s19
    buffer_load_dwordx4 v9, s[64:67], s42 offen lds
    v_cvt_pk_bf16_f32 v241, v214, v215
    v_cvt_pk_bf16_f32 v242, v216, v217
    v_cvt_pk_bf16_f32 v243, v218, v219
    v_mfma_f32_32x32x16_bf16 v[204:219], v[236:239], v[196:199], 0
    v_pk_mul_f32 v[220:221], v[220:221], v[138:139] op_sel_hi:[1,0]
    v_pk_mul_f32 v[222:223], v[222:223], v[138:139] op_sel_hi:[1,0]
    v_pk_mul_f32 v[224:225], v[224:225], v[138:139] op_sel_hi:[1,0]
    v_pk_mul_f32 v[226:227], v[226:227], v[138:139] op_sel_hi:[1,0]
    v_pk_mul_f32 v[228:229], v[228:229], v[138:139] op_sel_hi:[1,0]
    v_pk_mul_f32 v[230:231], v[230:231], v[138:139] op_sel_hi:[1,0]
    v_mfma_f32_32x32x16_bf16 v[204:219], v[240:243], v[200:203], v[204:219]
    v_pk_mul_f32 v[232:233], v[232:233], v[138:139] op_sel_hi:[1,0]
    v_pk_mul_f32 v[234:235], v[234:235], v[138:139] op_sel_hi:[1,0]
    v_cvt_pk_bf16_f32 v244, v220, v221
    v_cvt_pk_bf16_f32 v245, v222, v223
    v_cvt_pk_bf16_f32 v246, v224, v225
    v_cvt_pk_bf16_f32 v247, v226, v227
    v_cvt_pk_bf16_f32 v248, v228, v229
    v_cvt_pk_bf16_f32 v249, v230, v231
    s_add_u32 m0, s62, 77824
    s_mul_i32 s42, s17, 1344
    s_add_u32 s42, s42, s19
    buffer_load_dwordx4 v9, s[64:67], s42 offen lds
    v_cvt_pk_bf16_f32 v250, v232, v233
    v_cvt_pk_bf16_f32 v251, v234, v235
    v_mfma_f32_32x32x16_bf16 v[220:235], v[244:247], v[196:199], 0
    v_cvt_pk_bf16_f32 v172, v204, v205
    v_cvt_pk_bf16_f32 v173, v206, v207
    v_cvt_pk_bf16_f32 v174, v208, v209
    v_cvt_pk_bf16_f32 v175, v210, v211
    v_cvt_pk_bf16_f32 v176, v212, v213
    v_cvt_pk_bf16_f32 v177, v214, v215
    v_mfma_f32_32x32x16_bf16 v[220:235], v[248:251], v[200:203], v[220:235]
    v_cvt_pk_bf16_f32 v178, v216, v217
    v_cvt_pk_bf16_f32 v179, v218, v219
    v_mfma_f32_32x32x16_bf16 v[204:219], v[172:175], v[140:143], 0
    s_add_u32 m0, s62, 53248
    s_mul_i32 s42, s18, 1344
    s_add_u32 s42, s42, s19
    buffer_load_dwordx4 v9, s[64:67], s42 offen lds
    s_nop 4
    v_cvt_pk_bf16_f32 v180, v220, v221
    v_mfma_f32_32x32x16_bf16 v[204:219], v[176:179], v[144:147], v[204:219]
    v_cvt_pk_bf16_f32 v181, v222, v223
    v_cvt_pk_bf16_f32 v182, v224, v225
    v_cvt_pk_bf16_f32 v183, v226, v227
    v_cvt_pk_bf16_f32 v184, v228, v229
    v_cvt_pk_bf16_f32 v185, v230, v231
    v_cvt_pk_bf16_f32 v186, v232, v233
    v_cvt_pk_bf16_f32 v187, v234, v235
    v_mfma_f32_32x32x16_bf16 v[220:235], v[180:183], v[140:143], 0
    s_add_u32 s39, s62, 8192
    v_lshl_add_u32 v2, v1, 4, s39
    s_nop 1
    v_cvt_pk_bf16_f32 v236, v204, v205
    v_cvt_pk_bf16_f32 v237, v206, v207
    v_cvt_pk_bf16_f32 v238, v208, v209
    v_cvt_pk_bf16_f32 v239, v210, v211
    v_mfma_f32_32x32x16_bf16 v[220:235], v[184:187], v[144:147], v[220:235]
    v_cvt_pk_bf16_f32 v240, v212, v213
    v_cvt_pk_bf16_f32 v241, v214, v215
    v_cvt_pk_bf16_f32 v242, v216, v217
    v_cvt_pk_bf16_f32 v243, v218, v219
    ds_write_b128 v2, v[236:239] offset:0
    ds_write_b128 v2, v[240:243] offset:4096
    s_lshl_b32 s39, s34, 12
    s_add_u32 s39, s39, 8192
    v_lshl_add_u32 v3, v1, 4, s39
    s_nop 2
    v_cvt_pk_bf16_f32 v244, v220, v221
    v_cvt_pk_bf16_f32 v245, v222, v223
    v_cvt_pk_bf16_f32 v246, v224, v225
    v_cvt_pk_bf16_f32 v247, v226, v227
    v_cvt_pk_bf16_f32 v248, v228, v229
    v_cvt_pk_bf16_f32 v249, v230, v231
    v_cvt_pk_bf16_f32 v250, v232, v233
    v_cvt_pk_bf16_f32 v251, v234, v235
    ds_write_b128 v2, v[244:247] offset:8192
    ds_write_b128 v2, v[248:251] offset:12288
    s_waitcnt lgkmcnt(0)
    s_barrier
    ds_read_b128 v[204:207], v3 offset:0
    ds_read_b128 v[208:211], v3 offset:1024
    ds_read_b128 v[212:215], v3 offset:2048
    ds_read_b128 v[216:219], v3 offset:3072
    s_lshl_b32 s39, s33, 7
    s_add_u32 s39, s39, 0
    v_and_b32 v4, 15, v1
    v_lshl_add_u32 v4, v4, 2, s39
    s_lshr_b32 s39, s35, 2
    s_lshl_b32 s39, s39, 7
    s_add_u32 s39, s39, 2048
    v_and_b32 v8, 15, v1
    v_lshl_add_u32 v8, v8, 2, s39
    s_waitcnt lgkmcnt(0)
    v_mfma_f32_32x32x16_bf16 v[220:235], v[196:199], v[204:207], 0
    v_mov_b32 v204, -1
    v_mov_b32 v205, -1
    v_mov_b32 v206, -1
    v_mov_b32 v207, -1
    v_mfma_f32_32x32x16_bf16 v[220:235], v[196:199], v[208:211], v[220:235]
    v_mfma_f32_32x32x16_bf16 v[220:235], v[196:199], v[212:215], v[220:235]
    v_mfma_f32_32x32x16_bf16 v[220:235], v[196:199], v[216:219], v[220:235]
    s_nop 11
    v_cvt_pk_bf16_f32 v236, v220, v221
    v_cvt_pk_bf16_f32 v237, v222, v223
    v_cvt_pk_bf16_f32 v238, v224, v225
    v_cvt_pk_bf16_f32 v239, v226, v227
    global_store_dwordx4 v253, v[236:239], s[30:31] sc1
    global_store_dwordx4 v254, v[204:207], s[30:31] sc1
    global_store_dwordx4 v254, v[204:207], s[30:31] offset:1024 sc1
    global_load_dword v14, v4, s[30:31] sc1
    v_lshrrev_b32 v12, 4, v1
    v_lshlrev_b32 v9, 2, v12
    v_sub_u32 v9, v1, v9
    v_and_b32 v9, 15, v9
    v_mul_u32_u24 v12, 896, v12
    s_mul_i32 s39, s36, 224
    v_lshl_add_u32 v12, v9, 4, v12
    s_and_b32 s39, s39, 0xffffffc0
    v_add_u32 v9, s39, v12
    s_lshl_b32 s39, s33, 16
    s_add_u32 s39, s39, s62
    s_add_u32 s39, s39, 1048576
    s_mul_i32 s42, s34, 3584
    v_lshl_add_u32 v15, v1, 4, s39
    s_waitcnt vmcnt(4)
    s_barrier
    ds_read_b64_tr_b16 v[172:173], v6 offset:4096
    ds_read_b64_tr_b16 v[174:175], v6 offset:4352
    ds_read_b64_tr_b16 v[176:177], v6 offset:4608
    ds_read_b64_tr_b16 v[178:179], v6 offset:4864
    ds_read_b64_tr_b16 v[180:181], v6 offset:5120
    ds_read_b64_tr_b16 v[182:183], v6 offset:5376
    s_waitcnt lgkmcnt(4)
    v_mfma_f32_32x32x16_bf16 v[140:155], v[172:175], v[16:19], 0
    ds_read_b64_tr_b16 v[184:185], v6 offset:5632
    ds_read_b64_tr_b16 v[186:187], v6 offset:5888
    s_waitcnt lgkmcnt(4)
    v_mfma_f32_32x32x16_bf16 v[140:155], v[176:179], v[20:23], v[140:155]
    ds_read_b64_tr_b16 v[172:173], v6 offset:8192
    ds_read_b64_tr_b16 v[174:175], v6 offset:8448
    s_waitcnt lgkmcnt(4)
    v_mfma_f32_32x32x16_bf16 v[140:155], v[180:183], v[24:27], v[140:155]
    ds_read_b64_tr_b16 v[176:177], v6 offset:8704
    ds_read_b64_tr_b16 v[178:179], v6 offset:8960
    s_waitcnt lgkmcnt(4)
    v_mfma_f32_32x32x16_bf16 v[140:155], v[184:187], v[28:31], v[140:155]
    ds_read_b64_tr_b16 v[180:181], v6 offset:9216
    ds_read_b64_tr_b16 v[182:183], v6 offset:9472
    s_waitcnt lgkmcnt(4)
    v_mfma_f32_32x32x16_bf16 v[140:155], v[172:175], v[32:35], v[140:155]
    ds_read_b64_tr_b16 v[184:185], v6 offset:9728
    ds_read_b64_tr_b16 v[186:187], v6 offset:9984
    s_waitcnt lgkmcnt(4)
    v_mfma_f32_32x32x16_bf16 v[140:155], v[176:179], v[36:39], v[140:155]
    ds_read_b64_tr_b16 v[172:173], v6 offset:12288
    ds_read_b64_tr_b16 v[174:175], v6 offset:12544
    s_waitcnt lgkmcnt(4)
    v_mfma_f32_32x32x16_bf16 v[140:155], v[180:183], v[40:43], v[140:155]
    ds_read_b64_tr_b16 v[176:177], v6 offset:12800
    ds_read_b64_tr_b16 v[178:179], v6 offset:13056
    s_waitcnt lgkmcnt(4)
    v_mfma_f32_32x32x16_bf16 v[140:155], v[184:187], v[44:47], v[140:155]
    ds_read_b64_tr_b16 v[180:181], v6 offset:13312
    ds_read_b64_tr_b16 v[182:183], v6 offset:13568
    s_waitcnt lgkmcnt(4)
    v_mfma_f32_32x32x16_bf16 v[140:155], v[172:175], v[48:51], v[140:155]
    ds_read_b64_tr_b16 v[184:185], v6 offset:13824
    ds_read_b64_tr_b16 v[186:187], v6 offset:14080
    s_waitcnt lgkmcnt(4)
    v_mfma_f32_32x32x16_bf16 v[140:155], v[176:179], v[52:55], v[140:155]
    ds_read_b64_tr_b16 v[172:173], v6 offset:16384
    ds_read_b64_tr_b16 v[174:175], v6 offset:16640
    s_waitcnt lgkmcnt(4)
    v_mfma_f32_32x32x16_bf16 v[140:155], v[180:183], v[56:59], v[140:155]
    ds_read_b64_tr_b16 v[176:177], v6 offset:16896
    ds_read_b64_tr_b16 v[178:179], v6 offset:17152
    s_waitcnt lgkmcnt(4)
    v_mfma_f32_32x32x16_bf16 v[140:155], v[184:187], v[60:63], v[140:155]
    ds_read_b64_tr_b16 v[180:181], v6 offset:17408
    ds_read_b64_tr_b16 v[182:183], v6 offset:17664
    s_waitcnt lgkmcnt(4)
    v_mfma_f32_32x32x16_bf16 v[140:155], v[172:175], v[64:67], v[140:155]
    ds_read_b64_tr_b16 v[184:185], v6 offset:17920
    ds_read_b64_tr_b16 v[186:187], v6 offset:18176
    s_waitcnt lgkmcnt(4)
    v_mfma_f32_32x32x16_bf16 v[140:155], v[176:179], v[68:71], v[140:155]
    ds_read_b64_tr_b16 v[172:173], v6 offset:20480
    ds_read_b64_tr_b16 v[174:175], v6 offset:20736
    s_waitcnt lgkmcnt(4)
    v_mfma_f32_32x32x16_bf16 v[140:155], v[180:183], v[72:75], v[140:155]
    ds_read_b64_tr_b16 v[176:177], v6 offset:20992
    ds_read_b64_tr_b16 v[178:179], v6 offset:21248
    s_waitcnt lgkmcnt(4)
    v_mfma_f32_32x32x16_bf16 v[140:155], v[184:187], v[76:79], v[140:155]
    ds_read_b64_tr_b16 v[180:181], v6 offset:21504
    ds_read_b64_tr_b16 v[182:183], v6 offset:21760
    s_waitcnt lgkmcnt(4)
    v_mfma_f32_32x32x16_bf16 v[140:155], v[172:175], v[80:83], v[140:155]
    ds_read_b64_tr_b16 v[184:185], v6 offset:22016
    ds_read_b64_tr_b16 v[186:187], v6 offset:22272
    s_waitcnt lgkmcnt(4)
    v_mfma_f32_32x32x16_bf16 v[140:155], v[176:179], v[84:87], v[140:155]
    ds_read_b64_tr_b16 v[172:173], v6 offset:24576
    ds_read_b64_tr_b16 v[174:175], v6 offset:24832
    s_waitcnt lgkmcnt(4)
    v_mfma_f32_32x32x16_bf16 v[140:155], v[180:183], v[88:91], v[140:155]
    ds_read_b64_tr_b16 v[176:177], v6 offset:25088
    ds_read_b64_tr_b16 v[178:179], v6 offset:25344
    s_waitcnt lgkmcnt(4)
    v_mfma_f32_32x32x16_bf16 v[140:155], v[184:187], v[92:95], v[140:155]
    ds_read_b64_tr_b16 v[180:181], v6 offset:25600
    ds_read_b64_tr_b16 v[182:183], v6 offset:25856
    s_waitcnt lgkmcnt(4)
    v_mfma_f32_32x32x16_bf16 v[140:155], v[172:175], v[96:99], v[140:155]
    ds_read_b64_tr_b16 v[184:185], v6 offset:26112
    ds_read_b64_tr_b16 v[186:187], v6 offset:26368
    s_waitcnt lgkmcnt(4)
    v_mfma_f32_32x32x16_bf16 v[140:155], v[176:179], v[100:103], v[140:155]
    ds_read_b64_tr_b16 v[172:173], v6 offset:0
    ds_read_b64_tr_b16 v[174:175], v6 offset:256
    s_waitcnt lgkmcnt(4)
    v_mfma_f32_32x32x16_bf16 v[140:155], v[180:183], v[104:107], v[140:155]
    ds_read_b64_tr_b16 v[176:177], v6 offset:512
    ds_read_b64_tr_b16 v[178:179], v6 offset:768
    s_waitcnt lgkmcnt(4)
    v_mfma_f32_32x32x16_bf16 v[140:155], v[184:187], v[108:111], v[140:155]
    ds_read_b64_tr_b16 v[180:181], v6 offset:1024
    ds_read_b64_tr_b16 v[182:183], v6 offset:1280
    s_waitcnt lgkmcnt(4)
    v_mfma_f32_32x32x16_bf16 v[140:155], v[172:175], v[112:115], v[140:155]
    ds_read_b64_tr_b16 v[184:185], v6 offset:1536
    ds_read_b64_tr_b16 v[186:187], v6 offset:1792
    s_waitcnt lgkmcnt(4)
    v_mfma_f32_32x32x16_bf16 v[140:155], v[176:179], v[116:119], v[140:155]
    s_waitcnt lgkmcnt(2)
    v_mfma_f32_32x32x16_bf16 v[140:155], v[180:183], v[120:123], v[140:155]
    s_waitcnt lgkmcnt(0)
    v_mfma_f32_32x32x16_bf16 v[140:155], v[184:187], v[124:127], v[140:155]
    s_waitcnt vmcnt(0)
    s_barrier
    s_cmp_eq_u32 s34, 0
    s_cbranch_scc0 L_A_nopub2
    s_lshl_b32 s39, s32, 7
    s_lshl_b32 s40, s33, 2
    s_add_u32 s39, s39, s40
    s_add_u32 s39, s39, 2048
    v_mov_b32 v2, s39
    v_mov_b32 v3, 1
    s_mov_b64 exec, 1
    global_store_dword v2, v3, s[30:31] sc1
    s_mov_b64 exec, -1
L_A_nopub2:
    s_mov_b32 s60, 0
L_flA1:
    v_cmp_ne_u32 vcc, 1, v14
    s_nop 0
    s_cmp_eq_u64 vcc, 0
    s_cbranch_scc1 L_flokA1
    s_add_u32 s60, s60, 1
    s_cmp_gt_u32 s60, 30000
    s_cbranch_scc1 L_flokA1
    global_load_dword v14, v4, s[30:31] sc1
    s_waitcnt vmcnt(0)
    s_branch L_flA1
L_flokA1:
    v_mov_b32 v2, v15
    v_add_u32 v3, 16384, v15
    global_load_dwordx4 v[80:83], v2, s[30:31] sc1
    v_add_u32 v10, 32768, v15
    v_add_u32 v11, 49152, v15
    v_add_u32 v2, 4096, v2
    v_cvt_pk_bf16_f32 v172, v140, v141
    v_cvt_pk_bf16_f32 v173, v142, v143
    v_cvt_pk_bf16_f32 v174, v144, v145
    v_cvt_pk_bf16_f32 v175, v146, v147
    v_cvt_pk_bf16_f32 v178, v152, v153
    v_cvt_pk_bf16_f32 v179, v154, v155
    global_load_dwordx4 v[84:87], v3, s[30:31] sc1
    v_add_u32 v3, 4096, v3
    v_mfma_f32_32x32x16_bf16 v[204:219], v[188:191], v[172:175], 0
    v_cvt_pk_bf16_f32 v176, v148, v149
    v_cvt_pk_bf16_f32 v177, v150, v151
    v_cndmask_b32_e64 v178, v178, 0, s[52:53]
    v_cndmask_b32_e64 v179, v179, 0, s[52:53]
    v_mov_b32 v129, 0x7f800000
    v_mov_b32 v128, 0xff800000
    global_load_dwordx4 v[88:91], v10, s[30:31] sc1
    v_add_u32 v10, 4096, v10
    v_mfma_f32_32x32x16_bf16 v[204:219], v[192:195], v[176:179], v[204:219]
    global_load_dwordx4 v[92:95], v11, s[30:31] sc1
    v_add_u32 v11, 4096, v11
    s_nop 9
    v_min3_f32 v132, v204, v205, v206
    v_max3_f32 v130, v204, v205, v206
    v_min3_f32 v135, v207, v208, v209
    v_min3_f32 v132, v132, v210, v211
    v_cndmask_b32_e64 v184, v216, v129, s[52:53]
    global_load_dwordx4 v[96:99], v2, s[30:31] sc1
    v_add_u32 v2, 4096, v2
    v_cndmask_b32_e64 v185, v217, v129, s[52:53]
    v_cndmask_b32_e64 v186, v218, v129, s[52:53]
    v_cndmask_b32_e64 v187, v219, v129, s[52:53]
    v_max3_f32 v134, v207, v208, v209
    v_max3_f32 v130, v130, v210, v211
    v_min3_f32 v135, v135, v212, v213
    v_min3_f32 v132, v132, v214, v215
    v_cndmask_b32_e64 v180, v216, v128, s[52:53]
    global_load_dwordx4 v[100:103], v3, s[30:31] sc1
    v_add_u32 v3, 4096, v3
    v_cndmask_b32_e64 v181, v217, v128, s[52:53]
    v_cndmask_b32_e64 v182, v218, v128, s[52:53]
    v_cndmask_b32_e64 v183, v219, v128, s[52:53]
    v_max3_f32 v134, v134, v212, v213
    v_max3_f32 v130, v130, v214, v215
    v_min3_f32 v135, v135, v184, v185
    v_min3_f32 v132, v132, v186, v187
    v_max3_f32 v134, v134, v180, v181
    global_load_dwordx4 v[104:107], v10, s[30:31] sc1
    v_add_u32 v10, 4096, v10
    v_max3_f32 v130, v130, v182, v183
    v_min_f32 v132, v132, v135
    v_max_f32 v130, v130, v134
    v_mov_b32 v135, v132
    v_mov_b32 v134, v130
    s_nop 0
    v_permlane32_swap_b32 v132, v135
    global_load_dwordx4 v[108:111], v11, s[30:31] sc1
    v_add_u32 v11, 4096, v11
    v_permlane32_swap_b32 v130, v134
    v_min_f32 v132, v132, v135
    v_max_f32 v130, v130, v134
    v_mul_f32 v132, 0x3fb8aa3b, v132
    v_mul_f32 v130, 0xbfb8aa3b, v130
    v_pk_fma_f32 v[220:221], v[204:205], s[56:57], v[132:133] op_sel_hi:[1,1,0] neg_lo:[1,0,0] neg_hi:[1,0,0]
    v_pk_fma_f32 v[222:223], v[206:207], s[56:57], v[132:133] op_sel_hi:[1,1,0] neg_lo:[1,0,0] neg_hi:[1,0,0]
    global_load_dwordx4 v[112:115], v2, s[30:31] sc1
    v_add_u32 v2, 4096, v2
    v_pk_fma_f32 v[224:225], v[208:209], s[56:57], v[132:133] op_sel_hi:[1,1,0] neg_lo:[1,0,0] neg_hi:[1,0,0]
    v_pk_fma_f32 v[204:205], v[204:205], s[56:57], v[130:131] op_sel_hi:[1,1,0]
    v_pk_fma_f32 v[206:207], v[206:207], s[56:57], v[130:131] op_sel_hi:[1,1,0]
    v_pk_fma_f32 v[226:227], v[210:211], s[56:57], v[132:133] op_sel_hi:[1,1,0] neg_lo:[1,0,0] neg_hi:[1,0,0]
    v_pk_fma_f32 v[208:209], v[208:209], s[56:57], v[130:131] op_sel_hi:[1,1,0]
    v_exp_f32 v204, v204
    v_exp_f32 v205, v205
    global_load_dwordx4 v[116:119], v3, s[30:31] sc1
    v_add_u32 v3, 4096, v3
    v_exp_f32 v206, v206
    v_exp_f32 v207, v207
    v_exp_f32 v220, v220
    v_exp_f32 v221, v221
    global_load_dwordx4 v[120:123], v10, s[30:31] sc1
    v_add_u32 v10, 4096, v10
    v_exp_f32 v222, v222
    v_exp_f32 v223, v223
    v_pk_fma_f32 v[228:229], v[212:213], s[56:57], v[132:133] op_sel_hi:[1,1,0] neg_lo:[1,0,0] neg_hi:[1,0,0]
    v_pk_fma_f32 v[210:211], v[210:211], s[56:57], v[130:131] op_sel_hi:[1,1,0]
    v_exp_f32 v208, v208
    global_load_dwordx4 v[124:127], v11, s[30:31] sc1
    v_add_u32 v11, 4096, v11
    v_exp_f32 v209, v209
    v_exp_f32 v224, v224
    v_exp_f32 v225, v225
    v_pk_fma_f32 v[230:231], v[214:215], s[56:57], v[132:133] op_sel_hi:[1,1,0] neg_lo:[1,0,0] neg_hi:[1,0,0]
    v_pk_fma_f32 v[212:213], v[212:213], s[56:57], v[130:131] op_sel_hi:[1,1,0]
    global_load_dwordx4 v[156:159], v2, s[30:31] sc1
    v_exp_f32 v210, v210
    v_exp_f32 v211, v211
    v_pk_add_f32 v[136:137], v[204:205], v[206:207]
    v_exp_f32 v226, v226
    v_exp_f32 v227, v227
    global_load_dwordx4 v[160:163], v3, s[30:31] sc1
    v_pk_add_f32 v[138:139], v[220:221], v[222:223]
    v_pk_fma_f32 v[214:215], v[214:215], s[56:57], v[130:131] op_sel_hi:[1,1,0]
    v_exp_f32 v212, v212
    v_exp_f32 v213, v213
    v_pk_add_f32 v[136:137], v[136:137], v[208:209]
    v_exp_f32 v228, v228
    global_load_dwordx4 v[164:167], v10, s[30:31] sc1
    v_exp_f32 v229, v229
    v_pk_add_f32 v[138:139], v[138:139], v[224:225]
    v_pk_fma_f32 v[232:233], v[184:185], s[56:57], v[132:133] op_sel_hi:[1,1,0] neg_lo:[1,0,0] neg_hi:[1,0,0]
    v_pk_fma_f32 v[216:217], v[180:181], s[56:57], v[130:131] op_sel_hi:[1,1,0]
    v_exp_f32 v214, v214
    v_exp_f32 v215, v215
    global_load_dwordx4 v[168:171], v11, s[30:31] sc1
    v_pk_add_f32 v[136:137], v[136:137], v[210:211]
    v_exp_f32 v230, v230
    v_exp_f32 v231, v231
    v_pk_add_f32 v[138:139], v[138:139], v[226:227]
    v_pk_fma_f32 v[234:235], v[186:187], s[56:57], v[132:133] op_sel_hi:[1,1,0] neg_lo:[1,0,0] neg_hi:[1,0,0]
    v_pk_fma_f32 v[218:219], v[182:183], s[56:57], v[130:131] op_sel_hi:[1,1,0]
    v_exp_f32 v216, v216
    s_add_u32 m0, s62, 0
    s_add_u32 s43, s42, 0
    buffer_load_dwordx4 v9, s[72:75], s43 offen lds
    v_exp_f32 v217, v217
    v_pk_add_f32 v[136:137], v[136:137], v[212:213]
    v_exp_f32 v232, v232
    v_exp_f32 v233, v233
    s_add_u32 m0, s62, 4096
    s_add_u32 s43, s42, 14336
    buffer_load_dwordx4 v9, s[72:75], s43 offen lds
    v_pk_add_f32 v[138:139], v[138:139], v[228:229]
    v_exp_f32 v218, v218
    v_exp_f32 v219, v219
    v_pk_add_f32 v[136:137], v[136:137], v[214:215]
    v_exp_f32 v234, v234
    s_add_u32 m0, s62, 8192
    s_add_u32 s43, s42, 28672
    buffer_load_dwordx4 v9, s[72:75], s43 offen lds
    v_exp_f32 v235, v235
    v_pk_add_f32 v[138:139], v[138:139], v[230:231]
    v_pk_add_f32 v[136:137], v[136:137], v[216:217]
    v_pk_add_f32 v[138:139], v[138:139], v[232:233]
    v_pk_add_f32 v[136:137], v[136:137], v[218:219]
    v_pk_add_f32 v[138:139], v[138:139], v[234:235]
    s_add_u32 m0, s62, 12288
    s_add_u32 s43, s42, 43008
    buffer_load_dwordx4 v9, s[72:75], s43 offen lds
    v_add_f32 v136, v136, v137
    v_add_f32 v138, v138, v139
    v_mov_b32 v137, v136
    v_mov_b32 v139, v138
    s_nop 0
    v_permlane32_swap_b32 v136, v137
    s_add_u32 m0, s62, 16384
    s_add_u32 s43, s42, 57344
    buffer_load_dwordx4 v9, s[72:75], s43 offen lds
    v_permlane32_swap_b32 v138, v139
    v_add_f32 v136, v136, v137
    v_add_f32 v138, v138, v139
    v_rcp_f32 v136, v136
    v_rcp_f32 v138, v138
    s_add_u32 m0, s62, 20480
    s_add_u32 s43, s42, 71680
    buffer_load_dwordx4 v9, s[72:75], s43 offen lds
    v_pk_mul_f32 v[204:205], v[204:205], v[136:137] op_sel_hi:[1,0]
    v_pk_mul_f32 v[206:207], v[206:207], v[136:137] op_sel_hi:[1,0]
    v_pk_mul_f32 v[208:209], v[208:209], v[136:137] op_sel_hi:[1,0]
    v_pk_mul_f32 v[210:211], v[210:211], v[136:137] op_sel_hi:[1,0]
    v_pk_mul_f32 v[212:213], v[212:213], v[136:137] op_sel_hi:[1,0]
    v_pk_mul_f32 v[214:215], v[214:215], v[136:137] op_sel_hi:[1,0]
    v_pk_mul_f32 v[216:217], v[216:217], v[136:137] op_sel_hi:[1,0]
    s_add_u32 m0, s62, 24576
    s_add_u32 s43, s42, 86016
    buffer_load_dwordx4 v9, s[72:75], s43 offen lds
    v_pk_mul_f32 v[218:219], v[218:219], v[136:137] op_sel_hi:[1,0]
    v_pk_mul_f32 v[220:221], v[220:221], v[138:139] op_sel_hi:[1,0]
    v_pk_mul_f32 v[222:223], v[222:223], v[138:139] op_sel_hi:[1,0]
    v_pk_mul_f32 v[224:225], v[224:225], v[138:139] op_sel_hi:[1,0]
    v_pk_mul_f32 v[226:227], v[226:227], v[138:139] op_sel_hi:[1,0]
    v_pk_mul_f32 v[228:229], v[228:229], v[138:139] op_sel_hi:[1,0]
    v_pk_mul_f32 v[230:231], v[230:231], v[138:139] op_sel_hi:[1,0]
    s_add_u32 m0, s62, 28672
    s_add_u32 s43, s42, 100352
    buffer_load_dwordx4 v9, s[72:75], s43 offen lds
    v_pk_mul_f32 v[232:233], v[232:233], v[138:139] op_sel_hi:[1,0]
    v_pk_mul_f32 v[234:235], v[234:235], v[138:139] op_sel_hi:[1,0]
    v_cvt_pk_bf16_f32 v236, v204, v205
    v_cvt_pk_bf16_f32 v237, v206, v207
    v_cvt_pk_bf16_f32 v238, v208, v209
    v_cvt_pk_bf16_f32 v239, v210, v211
    v_cvt_pk_bf16_f32 v240, v212, v213
    s_add_u32 m0, s62, 32768
    s_add_u32 s43, s42, 114688
    buffer_load_dwordx4 v9, s[72:75], s43 offen lds
    v_cvt_pk_bf16_f32 v241, v214, v215
    v_cvt_pk_bf16_f32 v242, v216, v217
    v_cvt_pk_bf16_f32 v243, v218, v219
    v_cvt_pk_bf16_f32 v244, v220, v221
    v_cvt_pk_bf16_f32 v245, v222, v223
    v_cvt_pk_bf16_f32 v246, v224, v225
    v_cvt_pk_bf16_f32 v247, v226, v227
    s_add_u32 m0, s62, 36864
    s_add_u32 s43, s42, 129024
    buffer_load_dwordx4 v9, s[72:75], s43 offen lds
    v_cvt_pk_bf16_f32 v248, v228, v229
    v_cvt_pk_bf16_f32 v249, v230, v231
    v_cvt_pk_bf16_f32 v250, v232, v233
    v_cvt_pk_bf16_f32 v251, v234, v235
    s_add_u32 m0, s62, 40960
    s_add_u32 s43, s42, 143360
    buffer_load_dwordx4 v9, s[72:75], s43 offen lds
    s_add_u32 m0, s62, 45056
    s_add_u32 s43, s42, 157696
    buffer_load_dwordx4 v9, s[72:75], s43 offen lds
    s_add_u32 m0, s62, 49152
    s_add_u32 s43, s42, 172032
    buffer_load_dwordx4 v9, s[72:75], s43 offen lds
    s_add_u32 m0, s62, 53248
    s_add_u32 s43, s42, 186368
    buffer_load_dwordx4 v9, s[72:75], s43 offen lds
    s_add_u32 m0, s62, 57344
    s_add_u32 s43, s42, 200704
    buffer_load_dwordx4 v9, s[72:75], s43 offen lds
    s_waitcnt vmcnt(15)
    s_mov_b32 s60, 0
    v_mfma_f32_32x32x16_bf16 v[204:219], v[196:199], v[80:83], 0
    v_mfma_f32_32x32x16_bf16 v[204:219], v[196:199], v[84:87], v[204:219]
    v_mfma_f32_32x32x16_bf16 v[204:219], v[196:199], v[88:91], v[204:219]
    v_mfma_f32_32x32x16_bf16 v[204:219], v[196:199], v[92:95], v[204:219]
    v_mfma_f32_32x32x16_bf16 v[204:219], v[196:199], v[96:99], v[204:219]
    v_mfma_f32_32x32x16_bf16 v[204:219], v[196:199], v[100:103], v[204:219]
    v_mfma_f32_32x32x16_bf16 v[204:219], v[196:199], v[104:107], v[204:219]
    v_mfma_f32_32x32x16_bf16 v[204:219], v[196:199], v[108:111], v[204:219]
    v_mfma_f32_32x32x16_bf16 v[204:219], v[196:199], v[112:115], v[204:219]
    v_mfma_f32_32x32x16_bf16 v[204:219], v[196:199], v[116:119], v[204:219]
    v_mfma_f32_32x32x16_bf16 v[204:219], v[196:199], v[120:123], v[204:219]
    v_mfma_f32_32x32x16_bf16 v[204:219], v[196:199], v[124:127], v[204:219]
    v_mfma_f32_32x32x16_bf16 v[204:219], v[196:199], v[156:159], v[204:219]
    v_mfma_f32_32x32x16_bf16 v[204:219], v[196:199], v[160:163], v[204:219]
    v_mfma_f32_32x32x16_bf16 v[204:219], v[196:199], v[164:167], v[204:219]
    v_mfma_f32_32x32x16_bf16 v[204:219], v[196:199], v[168:171], v[204:219]
L_A_gchk:
    s_nop 11
    v_cmp_u_f32 vcc, v204, v204
    s_nop 0
    s_cmp_eq_u64 vcc, 0
    s_cbranch_scc1 L_A_gsumok
    s_add_u32 s60, s60, 1
    s_cmp_gt_u32 s60, 30000
    s_cbranch_scc1 L_A_gsumok
    v_mov_b32 v2, v15
    v_add_u32 v3, 16384, v15
    v_add_u32 v10, 32768, v15
    v_add_u32 v11, 49152, v15
    global_load_dwordx4 v[80:83], v2, s[30:31] sc1
    v_add_u32 v2, 4096, v2
    global_load_dwordx4 v[84:87], v3, s[30:31] sc1
    v_add_u32 v3, 4096, v3
    global_load_dwordx4 v[88:91], v10, s[30:31] sc1
    v_add_u32 v10, 4096, v10
    global_load_dwordx4 v[92:95], v11, s[30:31] sc1
    v_add_u32 v11, 4096, v11
    global_load_dwordx4 v[96:99], v2, s[30:31] sc1
    v_add_u32 v2, 4096, v2
    global_load_dwordx4 v[100:103], v3, s[30:31] sc1
    v_add_u32 v3, 4096, v3
    global_load_dwordx4 v[104:107], v10, s[30:31] sc1
    v_add_u32 v10, 4096, v10
    global_load_dwordx4 v[108:111], v11, s[30:31] sc1
    v_add_u32 v11, 4096, v11
    global_load_dwordx4 v[112:115], v2, s[30:31] sc1
    v_add_u32 v2, 4096, v2
    global_load_dwordx4 v[116:119], v3, s[30:31] sc1
    v_add_u32 v3, 4096, v3
    global_load_dwordx4 v[120:123], v10, s[30:31] sc1
    v_add_u32 v10, 4096, v10
    global_load_dwordx4 v[124:127], v11, s[30:31] sc1
    v_add_u32 v11, 4096, v11
    global_load_dwordx4 v[156:159], v2, s[30:31] sc1
    global_load_dwordx4 v[160:163], v3, s[30:31] sc1
    global_load_dwordx4 v[164:167], v10, s[30:31] sc1
    global_load_dwordx4 v[168:171], v11, s[30:31] sc1
    s_waitcnt vmcnt(0)
    v_mfma_f32_32x32x16_bf16 v[204:219], v[196:199], v[80:83], 0
    v_mfma_f32_32x32x16_bf16 v[204:219], v[196:199], v[84:87], v[204:219]
    v_mfma_f32_32x32x16_bf16 v[204:219], v[196:199], v[88:91], v[204:219]
    v_mfma_f32_32x32x16_bf16 v[204:219], v[196:199], v[92:95], v[204:219]
    v_mfma_f32_32x32x16_bf16 v[204:219], v[196:199], v[96:99], v[204:219]
    v_mfma_f32_32x32x16_bf16 v[204:219], v[196:199], v[100:103], v[204:219]
    v_mfma_f32_32x32x16_bf16 v[204:219], v[196:199], v[104:107], v[204:219]
    v_mfma_f32_32x32x16_bf16 v[204:219], v[196:199], v[108:111], v[204:219]
    v_mfma_f32_32x32x16_bf16 v[204:219], v[196:199], v[112:115], v[204:219]
    v_mfma_f32_32x32x16_bf16 v[204:219], v[196:199], v[116:119], v[204:219]
    v_mfma_f32_32x32x16_bf16 v[204:219], v[196:199], v[120:123], v[204:219]
    v_mfma_f32_32x32x16_bf16 v[204:219], v[196:199], v[124:127], v[204:219]
    v_mfma_f32_32x32x16_bf16 v[204:219], v[196:199], v[156:159], v[204:219]
    v_mfma_f32_32x32x16_bf16 v[204:219], v[196:199], v[160:163], v[204:219]
    v_mfma_f32_32x32x16_bf16 v[204:219], v[196:199], v[164:167], v[204:219]
    v_mfma_f32_32x32x16_bf16 v[204:219], v[196:199], v[168:171], v[204:219]
    s_nop 10
    s_branch L_A_gchk
L_A_gsumok:
    v_cvt_pk_bf16_f32 v172, v204, v205
    v_cvt_pk_bf16_f32 v173, v206, v207
    v_cvt_pk_bf16_f32 v174, v208, v209
    v_cvt_pk_bf16_f32 v175, v210, v211
    s_add_u32 s39, s62, 65536
    v_lshl_add_u32 v2, v1, 4, s39
    v_lshlrev_b32 v11, 4, v1
    v_add_u32 v11, 65536, v11
    ds_write_b128 v2, v[172:175]
    s_waitcnt vmcnt(0) lgkmcnt(0)
    s_barrier
    ds_read_b128 v[216:219], v11 offset:0
    ds_read_b128 v[220:223], v11 offset:1024
    ds_read_b128 v[224:227], v11 offset:2048
    ds_read_b128 v[228:231], v11 offset:3072
    global_load_dword v5, v8, s[30:31] sc1
    s_waitcnt lgkmcnt(0)
    v_mfma_f32_32x32x16_bf16 v[144:159], v[216:219], v[236:239], 0
    ds_read_b64_tr_b16 v[16:17], v13 offset:0
    ds_read_b64_tr_b16 v[18:19], v13 offset:2048
    ds_read_b64_tr_b16 v[20:21], v13 offset:4096
    ds_read_b64_tr_b16 v[22:23], v13 offset:6144
    ds_read_b64_tr_b16 v[24:25], v13 offset:7168
    ds_read_b64_tr_b16 v[26:27], v13 offset:9216
    v_mfma_f32_32x32x16_bf16 v[144:159], v[220:223], v[240:243], v[144:159]
    ds_read_b64_tr_b16 v[28:29], v13 offset:11264
    ds_read_b64_tr_b16 v[30:31], v13 offset:13312
    ds_read_b64_tr_b16 v[32:33], v13 offset:14336
    ds_read_b64_tr_b16 v[34:35], v13 offset:16384
    ds_read_b64_tr_b16 v[36:37], v13 offset:18432
    ds_read_b64_tr_b16 v[38:39], v13 offset:20480
    v_mfma_f32_32x32x16_bf16 v[144:159], v[224:227], v[244:247], v[144:159]
    v_mfma_f32_32x32x16_bf16 v[144:159], v[228:231], v[248:251], v[144:159]
    s_nop 11
    v_mov_b32 v10, v156
    v_mov_b32 v3, v156
    s_waitcnt lgkmcnt(4)
    ds_read_b64_tr_b16 v[40:41], v13 offset:21504
    ds_read_b64_tr_b16 v[42:43], v13 offset:23552
    ds_read_b64_tr_b16 v[44:45], v13 offset:25600
    ds_read_b64_tr_b16 v[46:47], v13 offset:27648
    ds_read_b64_tr_b16 v[48:49], v13 offset:28672
    ds_read_b64_tr_b16 v[50:51], v13 offset:30720
    ds_read_b64_tr_b16 v[52:53], v13 offset:32768
    ds_read_b64_tr_b16 v[54:55], v13 offset:34816
    v_permlane32_swap_b32 v10, v3
    ds_read_b64_tr_b16 v[56:57], v13 offset:35840
    v_add_f32 v10, 0x358637bd, v3
    ds_read_b64_tr_b16 v[58:59], v13 offset:37888
    v_rcp_f32 v10, v10
    ds_read_b64_tr_b16 v[60:61], v13 offset:39936
    ds_read_b64_tr_b16 v[62:63], v13 offset:41984
    v_pk_mul_f32 v[144:145], v[144:145], v[10:11] op_sel_hi:[1,0]
    v_pk_mul_f32 v[146:147], v[146:147], v[10:11] op_sel_hi:[1,0]
    v_pk_mul_f32 v[148:149], v[148:149], v[10:11] op_sel_hi:[1,0]
    v_pk_mul_f32 v[150:151], v[150:151], v[10:11] op_sel_hi:[1,0]
    v_pk_mul_f32 v[156:157], v[156:157], v[10:11] op_sel_hi:[1,0]
    v_pk_mul_f32 v[158:159], v[158:159], v[10:11] op_sel_hi:[1,0]
    v_pk_mul_f32 v[152:153], v[152:153], v[10:11] op_sel_hi:[1,0]
    v_pk_mul_f32 v[154:155], v[154:155], v[10:11] op_sel_hi:[1,0]
    v_cvt_pk_bf16_f32 v176, v144, v145
    v_cvt_pk_bf16_f32 v177, v146, v147
    v_cvt_pk_bf16_f32 v178, v148, v149
    v_cvt_pk_bf16_f32 v179, v150, v151
    v_cvt_pk_bf16_f32 v182, v156, v157
    v_cvt_pk_bf16_f32 v183, v158, v159
    v_cvt_pk_bf16_f32 v180, v152, v153
    v_cvt_pk_bf16_f32 v181, v154, v155
    v_cndmask_b32_e64 v182, v182, 0, s[52:53]
    v_cndmask_b32_e64 v183, v183, 0, s[52:53]
    s_waitcnt lgkmcnt(4)
    global_store_dwordx4 v254, v[176:179], s[30:31] sc1
    global_store_dwordx4 v254, v[180:183], s[30:31] offset:1024 sc1
    ds_read_b64_tr_b16 v[64:65], v13 offset:43008
    ds_read_b64_tr_b16 v[66:67], v13 offset:45056
    ds_read_b64_tr_b16 v[68:69], v13 offset:47104
    ds_read_b64_tr_b16 v[70:71], v13 offset:49152
    ds_read_b64_tr_b16 v[72:73], v13 offset:50176
    ds_read_b64_tr_b16 v[74:75], v13 offset:52224
    ds_read_b64_tr_b16 v[76:77], v13 offset:54272
    ds_read_b64_tr_b16 v[78:79], v13 offset:56320
    s_waitcnt lgkmcnt(0)
    s_barrier
    s_add_u32 m0, s62, 0
    s_add_u32 s43, s42, 200704
    buffer_load_dwordx4 v9, s[72:75], s43 offen lds
    s_add_u32 m0, s62, 4096
    s_add_u32 s43, s42, 215040
    buffer_load_dwordx4 v9, s[72:75], s43 offen lds
    s_add_u32 m0, s62, 8192
    s_add_u32 s43, s42, 229376
    buffer_load_dwordx4 v9, s[72:75], s43 offen lds
    s_add_u32 m0, s62, 12288
    s_add_u32 s43, s42, 243712
    buffer_load_dwordx4 v9, s[72:75], s43 offen lds
    s_add_u32 m0, s62, 16384
    s_add_u32 s43, s42, 258048
    buffer_load_dwordx4 v9, s[72:75], s43 offen lds
    s_add_u32 m0, s62, 20480
    s_add_u32 s43, s42, 272384
    buffer_load_dwordx4 v9, s[72:75], s43 offen lds
    s_add_u32 m0, s62, 24576
    s_add_u32 s43, s42, 286720
    buffer_load_dwordx4 v9, s[72:75], s43 offen lds
    s_add_u32 m0, s62, 28672
    s_add_u32 s43, s42, 301056
    buffer_load_dwordx4 v9, s[72:75], s43 offen lds
    s_add_u32 m0, s62, 32768
    s_add_u32 s43, s42, 315392
    buffer_load_dwordx4 v9, s[72:75], s43 offen lds
    s_add_u32 m0, s62, 36864
    s_add_u32 s43, s42, 329728
    buffer_load_dwordx4 v9, s[72:75], s43 offen lds
    s_add_u32 m0, s62, 40960
    s_add_u32 s43, s42, 344064
    buffer_load_dwordx4 v9, s[72:75], s43 offen lds
    s_add_u32 m0, s62, 45056
    s_add_u32 s43, s42, 358400
    buffer_load_dwordx4 v9, s[72:75], s43 offen lds
    s_add_u32 m0, s62, 49152
    s_add_u32 s43, s42, 372736
    buffer_load_dwordx4 v9, s[72:75], s43 offen lds
    s_add_u32 m0, s62, 53248
    s_add_u32 s43, s42, 387072
    buffer_load_dwordx4 v9, s[72:75], s43 offen lds
    s_add_u32 m0, s62, 57344
    s_add_u32 s43, s42, 401408
    buffer_load_dwordx4 v9, s[72:75], s43 offen lds
    s_waitcnt vmcnt(17)
    s_mov_b32 s60, 0
L_flA2:
    v_cmp_ne_u32 vcc, 1, v5
    s_nop 0
    s_cmp_eq_u64 vcc, 0
    s_cbranch_scc1 L_flokA2
    s_add_u32 s60, s60, 1
    s_cmp_gt_u32 s60, 30000
    s_cbranch_scc1 L_flokA2
    global_load_dword v5, v8, s[30:31] sc1
    s_waitcnt vmcnt(0)
    s_branch L_flA2
L_flokA2:
    s_lshl_b32 s39, s35, 15
    s_lshl_b32 s40, s34, 13
    s_add_u32 s39, s39, s40
    s_add_u32 s39, s39, 2097152
    v_lshl_add_u32 v2, v1, 4, s39
    v_add_u32 v3, 4096, v2
    s_mov_b32 s60, 0
    s_waitcnt vmcnt(15)
    global_load_dwordx4 v[184:187], v2, s[30:31] offset:0 sc1
    global_load_dwordx4 v[188:191], v2, s[30:31] offset:1024 sc1
    global_load_dwordx4 v[192:195], v2, s[30:31] offset:2048 sc1
    global_load_dwordx4 v[196:199], v2, s[30:31] offset:3072 sc1
    global_load_dwordx4 v[200:203], v3, s[30:31] offset:0 sc1
    global_load_dwordx4 v[204:207], v3, s[30:31] offset:1024 sc1
    global_load_dwordx4 v[208:211], v3, s[30:31] offset:2048 sc1
    global_load_dwordx4 v[212:215], v3, s[30:31] offset:3072 sc1
    s_waitcnt vmcnt(8)
    s_barrier
    ds_read_b64_tr_b16 v[80:81], v13 offset:0
    ds_read_b64_tr_b16 v[82:83], v13 offset:2048
    ds_read_b64_tr_b16 v[84:85], v13 offset:4096
    ds_read_b64_tr_b16 v[86:87], v13 offset:6144
    ds_read_b64_tr_b16 v[88:89], v13 offset:7168
    ds_read_b64_tr_b16 v[90:91], v13 offset:9216
    ds_read_b64_tr_b16 v[92:93], v13 offset:11264
    ds_read_b64_tr_b16 v[94:95], v13 offset:13312
    ds_read_b64_tr_b16 v[96:97], v13 offset:14336
    ds_read_b64_tr_b16 v[98:99], v13 offset:16384
    ds_read_b64_tr_b16 v[100:101], v13 offset:18432
    ds_read_b64_tr_b16 v[102:103], v13 offset:20480
    s_waitcnt lgkmcnt(4)
    ds_read_b64_tr_b16 v[104:105], v13 offset:21504
    ds_read_b64_tr_b16 v[106:107], v13 offset:23552
    ds_read_b64_tr_b16 v[108:109], v13 offset:25600
    ds_read_b64_tr_b16 v[110:111], v13 offset:27648
    ds_read_b64_tr_b16 v[112:113], v13 offset:28672
    ds_read_b64_tr_b16 v[114:115], v13 offset:30720
    ds_read_b64_tr_b16 v[116:117], v13 offset:32768
    ds_read_b64_tr_b16 v[118:119], v13 offset:34816
    ds_read_b64_tr_b16 v[120:121], v13 offset:35840
    ds_read_b64_tr_b16 v[122:123], v13 offset:37888
    ds_read_b64_tr_b16 v[124:125], v13 offset:39936
    ds_read_b64_tr_b16 v[126:127], v13 offset:41984
    s_waitcnt lgkmcnt(4)
    ds_read_b64_tr_b16 v[128:129], v13 offset:43008
    ds_read_b64_tr_b16 v[130:131], v13 offset:45056
    ds_read_b64_tr_b16 v[132:133], v13 offset:47104
    ds_read_b64_tr_b16 v[134:135], v13 offset:49152
    ds_read_b64_tr_b16 v[136:137], v13 offset:50176
    ds_read_b64_tr_b16 v[138:139], v13 offset:52224
    ds_read_b64_tr_b16 v[140:141], v13 offset:54272
    ds_read_b64_tr_b16 v[142:143], v13 offset:56320
    s_waitcnt vmcnt(0) lgkmcnt(0)
L_A_ochk:
    v_mov_b32 v12, 0
    v_max3_u32 v12, v12, v184, v185
    v_max3_u32 v12, v12, v186, v187
    v_max3_u32 v12, v12, v188, v189
    v_max3_u32 v12, v12, v190, v191
    v_max3_u32 v12, v12, v192, v193
    v_max3_u32 v12, v12, v194, v195
    v_max3_u32 v12, v12, v196, v197
    v_max3_u32 v12, v12, v198, v199
    v_max3_u32 v12, v12, v200, v201
    v_max3_u32 v12, v12, v202, v203
    v_max3_u32 v12, v12, v204, v205
    v_max3_u32 v12, v12, v206, v207
    v_max3_u32 v12, v12, v208, v209
    v_max3_u32 v12, v12, v210, v211
    v_max3_u32 v12, v12, v212, v213
    v_max3_u32 v12, v12, v214, v215
    v_cmp_eq_u32 vcc, -1, v12
    s_nop 0
    s_cmp_eq_u64 vcc, 0
    s_cbranch_scc1 L_A_oloadok
    s_add_u32 s60, s60, 1
    s_cmp_gt_u32 s60, 30000
    s_cbranch_scc1 L_A_oloadok
    global_load_dwordx4 v[184:187], v2, s[30:31] offset:0 sc1
    global_load_dwordx4 v[188:191], v2, s[30:31] offset:1024 sc1
    global_load_dwordx4 v[192:195], v2, s[30:31] offset:2048 sc1
    global_load_dwordx4 v[196:199], v2, s[30:31] offset:3072 sc1
    global_load_dwordx4 v[200:203], v3, s[30:31] offset:0 sc1
    global_load_dwordx4 v[204:207], v3, s[30:31] offset:1024 sc1
    global_load_dwordx4 v[208:211], v3, s[30:31] offset:2048 sc1
    global_load_dwordx4 v[212:215], v3, s[30:31] offset:3072 sc1
    s_waitcnt vmcnt(0)
    s_branch L_A_ochk
L_A_oloadok:
    s_lshl_b32 s39, s34, 13
    v_lshl_add_u32 v10, v1, 4, s39
    v_lshlrev_b32 v11, 4, v1
    s_barrier
    ds_write_b128 v10, v[184:187] offset:0
    ds_write_b128 v10, v[188:191] offset:1024
    ds_write_b128 v10, v[192:195] offset:2048
    ds_write_b128 v10, v[196:199] offset:3072
    ds_write_b128 v10, v[200:203] offset:4096
    ds_write_b128 v10, v[204:207] offset:5120
    ds_write_b128 v10, v[208:211] offset:6144
    ds_write_b128 v10, v[212:215] offset:7168
    s_waitcnt lgkmcnt(0)
    s_barrier
    ds_read_b128 v[144:147], v11 offset:0
    ds_read_b128 v[148:151], v11 offset:1024
    ds_read_b128 v[152:155], v11 offset:2048
    s_waitcnt lgkmcnt(2)
    v_mfma_f32_32x32x16_bf16 v[160:175], v[16:19], v[144:147], 0
    ds_read_b128 v[156:159], v11 offset:3072
    s_waitcnt lgkmcnt(2)
    v_mfma_f32_32x32x16_bf16 v[160:175], v[20:23], v[148:151], v[160:175]
    ds_read_b128 v[144:147], v11 offset:4096
    s_waitcnt lgkmcnt(2)
    v_mfma_f32_32x32x16_bf16 v[160:175], v[24:27], v[152:155], v[160:175]
    ds_read_b128 v[148:151], v11 offset:5120
    s_waitcnt lgkmcnt(2)
    v_mfma_f32_32x32x16_bf16 v[160:175], v[28:31], v[156:159], v[160:175]
    ds_read_b128 v[152:155], v11 offset:6144
    s_waitcnt lgkmcnt(2)
    v_mfma_f32_32x32x16_bf16 v[160:175], v[32:35], v[144:147], v[160:175]
    ds_read_b128 v[156:159], v11 offset:7168
    s_waitcnt lgkmcnt(2)
    v_mfma_f32_32x32x16_bf16 v[160:175], v[36:39], v[148:151], v[160:175]
    ds_read_b128 v[144:147], v11 offset:8192
    s_waitcnt lgkmcnt(2)
    v_mfma_f32_32x32x16_bf16 v[160:175], v[40:43], v[152:155], v[160:175]
    ds_read_b128 v[148:151], v11 offset:9216
    s_waitcnt lgkmcnt(2)
    v_mfma_f32_32x32x16_bf16 v[160:175], v[44:47], v[156:159], v[160:175]
    ds_read_b128 v[152:155], v11 offset:10240
    s_waitcnt lgkmcnt(2)
    v_mfma_f32_32x32x16_bf16 v[160:175], v[48:51], v[144:147], v[160:175]
    ds_read_b128 v[156:159], v11 offset:11264
    s_waitcnt lgkmcnt(2)
    v_mfma_f32_32x32x16_bf16 v[160:175], v[52:55], v[148:151], v[160:175]
    ds_read_b128 v[144:147], v11 offset:12288
    s_waitcnt lgkmcnt(2)
    v_mfma_f32_32x32x16_bf16 v[160:175], v[56:59], v[152:155], v[160:175]
    ds_read_b128 v[148:151], v11 offset:13312
    s_waitcnt lgkmcnt(2)
    v_mfma_f32_32x32x16_bf16 v[160:175], v[60:63], v[156:159], v[160:175]
    ds_read_b128 v[152:155], v11 offset:14336
    s_waitcnt lgkmcnt(2)
    v_mfma_f32_32x32x16_bf16 v[160:175], v[64:67], v[144:147], v[160:175]
    ds_read_b128 v[156:159], v11 offset:15360
    s_waitcnt lgkmcnt(2)
    v_mfma_f32_32x32x16_bf16 v[160:175], v[68:71], v[148:151], v[160:175]
    ds_read_b128 v[144:147], v11 offset:16384
    s_waitcnt lgkmcnt(2)
    v_mfma_f32_32x32x16_bf16 v[160:175], v[72:75], v[152:155], v[160:175]
    ds_read_b128 v[148:151], v11 offset:17408
    s_waitcnt lgkmcnt(2)
    v_mfma_f32_32x32x16_bf16 v[160:175], v[76:79], v[156:159], v[160:175]
    ds_read_b128 v[152:155], v11 offset:18432
    s_waitcnt lgkmcnt(2)
    v_mfma_f32_32x32x16_bf16 v[160:175], v[80:83], v[144:147], v[160:175]
    ds_read_b128 v[156:159], v11 offset:19456
    s_waitcnt lgkmcnt(2)
    v_mfma_f32_32x32x16_bf16 v[160:175], v[84:87], v[148:151], v[160:175]
    ds_read_b128 v[144:147], v11 offset:20480
    s_waitcnt lgkmcnt(2)
    v_mfma_f32_32x32x16_bf16 v[160:175], v[88:91], v[152:155], v[160:175]
    ds_read_b128 v[148:151], v11 offset:21504
    s_waitcnt lgkmcnt(2)
    v_mfma_f32_32x32x16_bf16 v[160:175], v[92:95], v[156:159], v[160:175]
    ds_read_b128 v[152:155], v11 offset:22528
    s_waitcnt lgkmcnt(2)
    v_mfma_f32_32x32x16_bf16 v[160:175], v[96:99], v[144:147], v[160:175]
    ds_read_b128 v[156:159], v11 offset:23552
    s_waitcnt lgkmcnt(2)
    v_mfma_f32_32x32x16_bf16 v[160:175], v[100:103], v[148:151], v[160:175]
    ds_read_b128 v[144:147], v11 offset:24576
    s_waitcnt lgkmcnt(2)
    v_mfma_f32_32x32x16_bf16 v[160:175], v[104:107], v[152:155], v[160:175]
    ds_read_b128 v[148:151], v11 offset:25600
    s_waitcnt lgkmcnt(2)
    v_mfma_f32_32x32x16_bf16 v[160:175], v[108:111], v[156:159], v[160:175]
    ds_read_b128 v[152:155], v11 offset:26624
    s_waitcnt lgkmcnt(2)
    v_mfma_f32_32x32x16_bf16 v[160:175], v[112:115], v[144:147], v[160:175]
    ds_read_b128 v[156:159], v11 offset:27648
    s_waitcnt lgkmcnt(2)
    v_mfma_f32_32x32x16_bf16 v[160:175], v[116:119], v[148:151], v[160:175]
    ds_read_b128 v[144:147], v11 offset:28672
    s_waitcnt lgkmcnt(2)
    v_mfma_f32_32x32x16_bf16 v[160:175], v[120:123], v[152:155], v[160:175]
    ds_read_b128 v[148:151], v11 offset:29696
    s_waitcnt lgkmcnt(2)
    v_mfma_f32_32x32x16_bf16 v[160:175], v[124:127], v[156:159], v[160:175]
    ds_read_b128 v[152:155], v11 offset:30720
    s_waitcnt lgkmcnt(2)
    v_mfma_f32_32x32x16_bf16 v[160:175], v[128:131], v[144:147], v[160:175]
    ds_read_b128 v[156:159], v11 offset:31744
    s_waitcnt lgkmcnt(2)
    v_mfma_f32_32x32x16_bf16 v[160:175], v[132:135], v[148:151], v[160:175]
    s_waitcnt lgkmcnt(1)
    v_mfma_f32_32x32x16_bf16 v[160:175], v[136:139], v[152:155], v[160:175]
    s_waitcnt lgkmcnt(0)
    v_mfma_f32_32x32x16_bf16 v[160:175], v[140:143], v[156:159], v[160:175]
    v_and_b32 v2, 31, v1
    v_mul_u32_u24 v2, 240, v2
    v_lshrrev_b32 v3, 5, v1
    s_mul_i32 s39, s34, 56
    v_lshl_add_u32 v2, v3, 3, v2
    s_add_u32 s39, s39, 69632
    v_add_u32 v2, s39, v2
    s_nop 4
    v_cvt_pk_bf16_f32 v176, v160, v161
    v_cvt_pk_bf16_f32 v177, v162, v163
    v_cvt_pk_bf16_f32 v178, v164, v165
    v_cvt_pk_bf16_f32 v179, v166, v167
    ds_write_b64 v2, v[176:177] offset:0
    v_cvt_pk_bf16_f32 v180, v168, v169
    v_cvt_pk_bf16_f32 v181, v170, v171
    ds_write_b64 v2, v[178:179] offset:16
    v_cvt_pk_bf16_f32 v182, v172, v173
    v_cvt_pk_bf16_f32 v183, v174, v175
    ds_write_b64 v2, v[180:181] offset:32
    s_mov_b32 exec_hi, 0
    ds_write_b64 v2, v[182:183] offset:48
    s_mov_b32 exec_hi, -1
    v_mul_u32_u24 v4, 4682, v0
    v_lshrrev_b32 v4, 16, v4
    v_mul_u32_u24 v5, 14, v4
    s_lshl_b32 s39, s35, 5
    v_sub_u32 v5, v0, v5
    v_mul_u32_u24 v7, 1792, v4
    s_mul_i32 s39, s39, 1792
    s_mul_i32 s40, s36, 224
    v_mul_u32_u24 v6, 240, v4
    v_lshl_add_u32 v7, v5, 4, v7
    s_add_u32 s39, s39, s40
    v_lshl_add_u32 v6, v5, 4, v6
    v_add_u32 v7, s39, v7
    v_add_u32 v6, 69632, v6
    v_add_u32 v8, 28672, v7
    s_waitcnt lgkmcnt(0)
    s_barrier
    v_cmp_gt_u32 vcc, 224, v0
    s_nop 0
    s_and_saveexec_b64 s[40:41], vcc
    s_cbranch_execz L_A_end
    ds_read_b128 v[144:147], v6
    ds_read_b128 v[148:151], v6 offset:3840
    s_waitcnt lgkmcnt(0)
    global_store_dwordx4 v7, v[144:147], s[26:27]
    global_store_dwordx4 v8, v[148:151], s[26:27]
L_A_end:
    s_endpgm
L_ctrl:
    s_waitcnt lgkmcnt(0)
    v_lshlrev_b32 v1, 5, v0
    v_mov_b32 v4, 0
    v_mov_b32 v5, 0
    v_mov_b32 v6, 0
    v_mov_b32 v7, 0
    global_store_dwordx4 v1, v[4:7], s[30:31] sc1
    global_store_dwordx4 v1, v[4:7], s[30:31] offset:16 sc1
    s_waitcnt vmcnt(0)
    s_barrier
    v_mov_b32 v2, 0
    v_mov_b32 v3, 1
    v_cmp_eq_u32 vcc, 0, v0
    s_nop 0
    s_and_saveexec_b64 s[40:41], vcc
    s_cbranch_execz L_ctrl_end
    global_store_dword v2, v3, s[28:29] sc1
L_ctrl_end:
    s_endpgm
L_exit:
    s_endpgm
.section .rodata,"a"
.p2align 6
.amdhsa_kernel concat_heads__linear_kernel_hedgehog__ssm_conv_s4d__prompt_kernel
  .amdhsa_next_free_vgpr 256
  .amdhsa_next_free_sgpr 102
  .amdhsa_accum_offset 256
  .amdhsa_group_segment_fixed_size 0
  .amdhsa_kernarg_size 112
  .amdhsa_user_sgpr_count 2
  .amdhsa_user_sgpr_kernarg_segment_ptr 1
  .amdhsa_system_sgpr_workgroup_id_x 1
.end_amdhsa_kernel
```
